```python
import torch

def _softmax(x, axis=-1):
    return torch.softmax(x, dim=axis)
def _gelu(x):
    return torch.nn.functional.gelu(x, approximate="tanh")
def _silu(x):
    return torch.nn.functional.silu(x)
def _sigmoid(x):
    return torch.sigmoid(x)
def _layernorm(x, axis=-1, eps=1e-5):
    m = x.mean(dim=axis, keepdim=True)
    v = x.var(dim=axis, keepdim=True, unbiased=False)
    return (x - m) / torch.sqrt(v + eps)
def _scatter_add(tgt, idx, src, axis=0):
    return tgt.clone().index_add_(axis, idx, src)
def _segment_sum(src, seg, n):
    out = torch.zeros((n,) + src.shape[1:], dtype=src.dtype)
    return out.index_add_(0, seg, src)
def _pad(x, pw):
    flat = tuple(v for pair in reversed(pw) for v in pair)
    return torch.nn.functional.pad(x, flat)

kernel_name = 'recurrent_scan__softmax_full_mha__dense_activation_relu__prompt'

def setup_inputs():

    _w = (lambda a: (lambda t: t.to(torch.bfloat16) if t.is_floating_point() else t)(torch.as_tensor(a)))
    def _A_setup():
        B, S, D = 1, 2048, 512
        return {
            "x": _w((lambda *s: torch.randn(*s, dtype=torch.bfloat16) * 0.05)(B, S, D)),
            "wqkv": _w((lambda *s: torch.randn(*s, dtype=torch.bfloat16) * 0.05)(D, 3 * D)),
            "wo": _w((lambda *s: torch.randn(*s, dtype=torch.bfloat16) * 0.05)(D, D)),
        }
    _A_in = _A_setup()

    def _B_setup():
        B, S, D, Dff = 1, 2048, 512, 1792
        return {
            "x": _w((lambda *s: torch.randn(*s, dtype=torch.bfloat16) * 0.05)(B, S, D)),
            "w1": _w((lambda *s: torch.randn(*s, dtype=torch.bfloat16) * 0.05)(D, Dff)),
            "w2": _w((lambda *s: torch.randn(*s, dtype=torch.bfloat16) * 0.05)(Dff, D)),
        }
    _B_in = _B_setup()

    return {
        "A_x": _A_in["x"],
        "A_wqkv": _A_in["wqkv"],
        "A_wo": _A_in["wo"],
        "B_x": _B_in["x"],
        "B_w1": _B_in["w1"],
        "B_w2": _B_in["w2"],
    }

def reference(A_x, A_wqkv, A_wo, B_x, B_w1, B_w2):
    def _A_ref(x, wqkv, wo):
        B, S, D = x.shape
        H = 32; Dh = D // H
        qkv = (lambda x, *d: x.permute(*d))((x @ wqkv).reshape(B, S, 3, H, Dh), 2, 0, 3, 1, 4)
        q, k, v = qkv[0], qkv[1], qkv[2]
        scale = Dh ** -0.5
        scores = torch.einsum("bhqd,bhkd->bhqk", q, k) * scale
        p = _softmax(scores, axis=-1)
        o = torch.einsum("bhqk,bhkd->bhqd", p, v)
        return (lambda x, *d: x.permute(*d))(o, 0, 2, 1, 3).reshape(B, S, D) @ wo

    def _B_ref(x, w1, w2):
        h = torch.einsum("bsd,df->bsf", x, w1)
        zero = torch.zeros_like(h)
        h = torch.maximum(h, zero)
        return torch.einsum("bsf,fd->bsd", h, w2)

    x = A_x
    xn = _layernorm(x, axis=-1)
    s = _A_ref(xn, A_wqkv, A_wo)
    g = _silu(_B_ref(xn, B_w1, B_w2))
    return x + s * g
```

```asm
; @launch grid=(256,1,1) block=(768,1,1) lds=163840
.amdgcn_target "amdgcn-amd-amdhsa--gfx950"
.text
.globl recurrent_scan__softmax_full_mha__dense_activation_relu__prompt_kernel
.p2align 8
.type recurrent_scan__softmax_full_mha__dense_activation_relu__prompt_kernel,@function
recurrent_scan__softmax_full_mha__dense_activation_relu__prompt_kernel:
L_start:
    s_cmp_ge_u32 s2, 256
    s_cbranch_scc1 L_end
    s_load_dwordx16 s[4:19], s[0:1], 0
    s_load_dwordx2 s[20:21], s[0:1], 64
    v_lshrrev_b32 v1, 6, v0
    v_and_b32 v0, 63, v0
    s_and_b32 s3, s2, 3
    v_readfirstlane_b32 s38, v1
    s_lshl_b32 s3, s3, 2
    s_bfe_u32 s36, s2, 0x20003
    s_add_u32 s36, s36, s3
    s_bfe_u32 s3, s2, 0x10002
    s_lshl_b32 s3, s3, 3
    s_lshr_b32 s37, s2, 5
    s_add_u32 s37, s37, s3
    s_and_b32 s39, s38, 3
    v_lshlrev_b32 v1, 4, v0
    s_cmp_ge_u32 s38, 4
    s_cbranch_scc1 L_cons
    s_setprio 1
    v_lshrrev_b32 v7, 3, v0
    v_lshlrev_b32 v7, 10, v7
    v_and_b32 v8, 7, v0
    v_lshrrev_b32 v9, 4, v0
    v_xor_b32 v8, v8, v9
    v_lshl_add_u32 v2, v8, 4, v7
    v_xor_b32 v3, 64, v2
    s_lshl_b32 s43, s36, 2
    s_add_u32 s43, s43, s39
    s_lshl_b32 s43, s43, 15
    s_lshl_b32 s44, s39, 12
    v_lshrrev_b32 v7, 2, v0
    v_and_b32 v8, 3, v0
    v_lshlrev_b32 v8, 4, v8
    s_movk_i32 s47, 3072
    v_mad_u32_u24 v4, v7, s47, v8
    s_mul_i32 s45, s39, 49152
    s_mul_i32 s47, s37, 192
    s_add_u32 s45, s45, s47
    s_mov_b32 s26, 0x200000
    s_mov_b32 s27, 0x20000
    s_mov_b32 s30, 0x180000
    s_mov_b32 s31, 0x20000
    s_waitcnt lgkmcnt(0)
    s_mov_b64 s[24:25], s[4:5]
    s_mov_b64 s[28:29], s[6:7]
    s_mul_i32 s59, s39, 3072
    s_mul_i32 s42, s37, 1
    s_mul_i32 s48, s36, 1
    s_add_u32 s42, s42, s48
    s_add_u32 s48, s42, 0
    s_and_b32 s48, s48, 7
    s_mul_i32 s48, s48, 128
    s_add_u32 s48, s48, s43
    s_add_u32 m0, s44, 0
    s_add_u32 s47, s48, 0
    buffer_load_dwordx4 v2, s[24:27], s47 offen lds
    s_add_u32 m0, s44, 1024
    s_add_u32 s47, s48, 8192
    buffer_load_dwordx4 v3, s[24:27], s47 offen lds
    s_add_u32 m0, s44, 2048
    s_add_u32 s47, s48, 16384
    buffer_load_dwordx4 v2, s[24:27], s47 offen lds
    s_add_u32 m0, s44, 3072
    s_add_u32 s47, s48, 24576
    buffer_load_dwordx4 v3, s[24:27], s47 offen lds
    s_add_u32 s48, s42, 0
    s_and_b32 s48, s48, 7
    s_mul_i32 s48, s48, 196608
    s_add_u32 s48, s48, s45
    s_add_u32 m0, s59, 98304
    s_add_u32 s47, s48, 0
    buffer_load_dwordx4 v4, s[28:31], s47 offen offset:0 lds
    s_add_u32 m0, s59, 99328
    s_add_u32 s47, s47, 64
    buffer_load_dwordx4 v4, s[28:31], s47 offen lds
    s_add_u32 m0, s59, 100352
    s_add_u32 s47, s47, 64
    buffer_load_dwordx4 v4, s[28:31], s47 offen lds
    s_add_u32 s48, s42, 1
    s_and_b32 s48, s48, 7
    s_mul_i32 s48, s48, 128
    s_add_u32 s48, s48, s43
    s_add_u32 m0, s44, 16384
    s_add_u32 s47, s48, 0
    buffer_load_dwordx4 v2, s[24:27], s47 offen lds
    s_add_u32 m0, s44, 17408
    s_add_u32 s47, s48, 8192
    buffer_load_dwordx4 v3, s[24:27], s47 offen lds
    s_add_u32 m0, s44, 18432
    s_add_u32 s47, s48, 16384
    buffer_load_dwordx4 v2, s[24:27], s47 offen lds
    s_add_u32 m0, s44, 19456
    s_add_u32 s47, s48, 24576
    buffer_load_dwordx4 v3, s[24:27], s47 offen lds
    s_add_u32 s48, s42, 1
    s_and_b32 s48, s48, 7
    s_mul_i32 s48, s48, 196608
    s_add_u32 s48, s48, s45
    s_add_u32 m0, s59, 110592
    s_add_u32 s47, s48, 0
    buffer_load_dwordx4 v4, s[28:31], s47 offen offset:0 lds
    s_add_u32 m0, s59, 111616
    s_add_u32 s47, s47, 64
    buffer_load_dwordx4 v4, s[28:31], s47 offen lds
    s_add_u32 m0, s59, 112640
    s_add_u32 s47, s47, 64
    buffer_load_dwordx4 v4, s[28:31], s47 offen lds
    s_and_b32 s3, s2, 7
    s_lshl_b32 s3, s3, 2
    s_bfe_u32 s40, s2, 0x20003
    s_add_u32 s40, s40, s3
    s_lshr_b32 s41, s2, 5
    s_mov_b32 s22, 0x1300000
    s_mov_b32 s23, 0x20000
    s_load_dwordx2 s[18:19], s[20:21], 0
    s_movk_i32 s47, 3584
    v_mad_u32_u24 v5, v7, s47, v8
    s_mul_i32 s46, s39, 57344
    s_lshl_b32 s47, s37, 8
    s_add_u32 s46, s46, s47
    v_and_b32 v10, 7, v0
    v_lshlrev_b32 v10, 2, v10
    v_add_u32 v10, 150544, v10
    s_lshl_b32 s49, s39, 2
    s_add_u32 s49, s49, 150528
    v_cmp_eq_u32 vcc, 0, v0
    v_mov_b32 v11, 0x7ffffff0
    v_mov_b32 v12, s49
    v_lshlrev_b32 v6, 3, v0
    v_cndmask_b32 v11, v11, v12, vcc
    s_mov_b32 s32, s12
    s_mov_b32 s33, s13
    s_mov_b32 s34, 0x1c0000
    s_mov_b32 s35, 0x20000
    s_mov_b32 s60, s49
    s_lshl_b32 s61, s2, 7
    s_add_u32 s61, s61, 589824
    v_mov_b32 v9, 0
    v_lshlrev_b32 v14, 2, v0
    s_mov_b64 exec, 0xffffffff
    buffer_store_dword v0, v14, s[20:23], s61 offen
    s_mov_b64 exec, -1
    s_waitcnt vmcnt(8)
    s_barrier
    s_add_u32 s48, s42, 2
    s_and_b32 s48, s48, 7
    s_mul_i32 s48, s48, 128
    s_add_u32 s48, s48, s43
    s_add_u32 m0, s44, 32768
    s_add_u32 s47, s48, 0
    buffer_load_dwordx4 v2, s[24:27], s47 offen lds
    s_add_u32 m0, s44, 33792
    s_add_u32 s47, s48, 8192
    buffer_load_dwordx4 v3, s[24:27], s47 offen lds
    s_add_u32 m0, s44, 34816
    s_add_u32 s47, s48, 16384
    buffer_load_dwordx4 v2, s[24:27], s47 offen lds
    s_add_u32 m0, s44, 35840
    s_add_u32 s47, s48, 24576
    buffer_load_dwordx4 v3, s[24:27], s47 offen lds
    s_add_u32 s48, s42, 2
    s_and_b32 s48, s48, 7
    s_mul_i32 s48, s48, 196608
    s_add_u32 s48, s48, s45
    s_add_u32 m0, s59, 122880
    s_add_u32 s47, s48, 0
    buffer_load_dwordx4 v4, s[28:31], s47 offen offset:0 lds
    s_add_u32 m0, s59, 123904
    s_add_u32 s47, s47, 64
    buffer_load_dwordx4 v4, s[28:31], s47 offen lds
    s_add_u32 m0, s59, 124928
    s_add_u32 s47, s47, 64
    buffer_load_dwordx4 v4, s[28:31], s47 offen lds
    s_waitcnt vmcnt(8)
    s_barrier
    s_add_u32 s48, s42, 3
    s_and_b32 s48, s48, 7
    s_mul_i32 s48, s48, 128
    s_add_u32 s48, s48, s43
    s_add_u32 m0, s44, 49152
    s_add_u32 s47, s48, 0
    buffer_load_dwordx4 v2, s[24:27], s47 offen lds
    s_add_u32 m0, s44, 50176
    s_add_u32 s47, s48, 8192
    buffer_load_dwordx4 v3, s[24:27], s47 offen lds
    s_add_u32 m0, s44, 51200
    s_add_u32 s47, s48, 16384
    buffer_load_dwordx4 v2, s[24:27], s47 offen lds
    s_add_u32 m0, s44, 52224
    s_add_u32 s47, s48, 24576
    buffer_load_dwordx4 v3, s[24:27], s47 offen lds
    s_add_u32 s48, s42, 3
    s_and_b32 s48, s48, 7
    s_mul_i32 s48, s48, 196608
    s_add_u32 s48, s48, s45
    s_add_u32 m0, s59, 135168
    s_add_u32 s47, s48, 0
    buffer_load_dwordx4 v4, s[28:31], s47 offen offset:0 lds
    s_add_u32 m0, s59, 136192
    s_add_u32 s47, s47, 64
    buffer_load_dwordx4 v4, s[28:31], s47 offen lds
    s_add_u32 m0, s59, 137216
    s_add_u32 s47, s47, 64
    buffer_load_dwordx4 v4, s[28:31], s47 offen lds
    s_add_u32 s48, s42, 4
    s_and_b32 s48, s48, 7
    s_mul_i32 s48, s48, 128
    s_add_u32 s48, s48, s43
    s_add_u32 m0, s44, 65536
    s_add_u32 s47, s48, 0
    buffer_load_dwordx4 v2, s[24:27], s47 offen lds
    s_add_u32 m0, s44, 66560
    s_add_u32 s47, s48, 8192
    buffer_load_dwordx4 v3, s[24:27], s47 offen lds
    s_add_u32 m0, s44, 67584
    s_add_u32 s47, s48, 16384
    buffer_load_dwordx4 v2, s[24:27], s47 offen lds
    s_add_u32 m0, s44, 68608
    s_add_u32 s47, s48, 24576
    buffer_load_dwordx4 v3, s[24:27], s47 offen lds
    s_add_u32 s48, s42, 4
    s_and_b32 s48, s48, 7
    s_mul_i32 s48, s48, 196608
    s_add_u32 s48, s48, s45
    s_add_u32 m0, s59, 98304
    s_add_u32 s47, s48, 0
    buffer_load_dwordx4 v4, s[28:31], s47 offen offset:0 lds
    s_add_u32 m0, s59, 99328
    s_add_u32 s47, s47, 64
    buffer_load_dwordx4 v4, s[28:31], s47 offen lds
    s_add_u32 m0, s59, 100352
    s_add_u32 s47, s47, 64
    buffer_load_dwordx4 v4, s[28:31], s47 offen lds
    s_waitcnt vmcnt(14)
    s_barrier
    s_add_u32 s48, s42, 5
    s_and_b32 s48, s48, 7
    s_mul_i32 s48, s48, 128
    s_add_u32 s48, s48, s43
    s_add_u32 m0, s44, 0
    s_add_u32 s47, s48, 0
    buffer_load_dwordx4 v2, s[24:27], s47 offen lds
    s_add_u32 m0, s44, 1024
    s_add_u32 s47, s48, 8192
    buffer_load_dwordx4 v3, s[24:27], s47 offen lds
    s_add_u32 m0, s44, 2048
    s_add_u32 s47, s48, 16384
    buffer_load_dwordx4 v2, s[24:27], s47 offen lds
    s_add_u32 m0, s44, 3072
    s_add_u32 s47, s48, 24576
    buffer_load_dwordx4 v3, s[24:27], s47 offen lds
    s_add_u32 s48, s42, 5
    s_and_b32 s48, s48, 7
    s_mul_i32 s48, s48, 196608
    s_add_u32 s48, s48, s45
    s_add_u32 m0, s59, 110592
    s_add_u32 s47, s48, 0
    buffer_load_dwordx4 v4, s[28:31], s47 offen offset:0 lds
    s_add_u32 m0, s59, 111616
    s_add_u32 s47, s47, 64
    buffer_load_dwordx4 v4, s[28:31], s47 offen lds
    s_add_u32 m0, s59, 112640
    s_add_u32 s47, s47, 64
    buffer_load_dwordx4 v4, s[28:31], s47 offen lds
    s_waitcnt vmcnt(14)
    s_barrier
    s_add_u32 s48, s42, 6
    s_and_b32 s48, s48, 7
    s_mul_i32 s48, s48, 128
    s_add_u32 s48, s48, s43
    s_add_u32 m0, s44, 16384
    s_add_u32 s47, s48, 0
    buffer_load_dwordx4 v2, s[24:27], s47 offen lds
    s_add_u32 m0, s44, 17408
    s_add_u32 s47, s48, 8192
    buffer_load_dwordx4 v3, s[24:27], s47 offen lds
    s_add_u32 m0, s44, 18432
    s_add_u32 s47, s48, 16384
    buffer_load_dwordx4 v2, s[24:27], s47 offen lds
    s_add_u32 m0, s44, 19456
    s_add_u32 s47, s48, 24576
    buffer_load_dwordx4 v3, s[24:27], s47 offen lds
    s_add_u32 s48, s42, 6
    s_and_b32 s48, s48, 7
    s_mul_i32 s48, s48, 196608
    s_add_u32 s48, s48, s45
    s_add_u32 m0, s59, 122880
    s_add_u32 s47, s48, 0
    buffer_load_dwordx4 v4, s[28:31], s47 offen offset:0 lds
    s_add_u32 m0, s59, 123904
    s_add_u32 s47, s47, 64
    buffer_load_dwordx4 v4, s[28:31], s47 offen lds
    s_add_u32 m0, s59, 124928
    s_add_u32 s47, s47, 64
    buffer_load_dwordx4 v4, s[28:31], s47 offen lds
    s_waitcnt vmcnt(14)
    s_barrier
    s_add_u32 s48, s42, 7
    s_and_b32 s48, s48, 7
    s_mul_i32 s48, s48, 128
    s_add_u32 s48, s48, s43
    s_add_u32 m0, s44, 32768
    s_add_u32 s47, s48, 0
    buffer_load_dwordx4 v2, s[24:27], s47 offen lds
    s_add_u32 m0, s44, 33792
    s_add_u32 s47, s48, 8192
    buffer_load_dwordx4 v3, s[24:27], s47 offen lds
    s_add_u32 m0, s44, 34816
    s_add_u32 s47, s48, 16384
    buffer_load_dwordx4 v2, s[24:27], s47 offen lds
    s_add_u32 m0, s44, 35840
    s_add_u32 s47, s48, 24576
    buffer_load_dwordx4 v3, s[24:27], s47 offen lds
    s_add_u32 s48, s42, 7
    s_and_b32 s48, s48, 7
    s_mul_i32 s48, s48, 196608
    s_add_u32 s48, s48, s45
    s_add_u32 m0, s59, 135168
    s_add_u32 s47, s48, 0
    buffer_load_dwordx4 v4, s[28:31], s47 offen offset:0 lds
    s_add_u32 m0, s59, 136192
    s_add_u32 s47, s47, 64
    buffer_load_dwordx4 v4, s[28:31], s47 offen lds
    s_add_u32 m0, s59, 137216
    s_add_u32 s47, s47, 64
    buffer_load_dwordx4 v4, s[28:31], s47 offen lds
    s_waitcnt vmcnt(14)
    s_barrier
    s_cmp_ge_u32 s37, 14
    s_cbranch_scc1 L_idle_bar
    s_add_u32 s48, s42, 7
    s_and_b32 s48, s48, 7
    s_mul_i32 s48, s48, 229376
    s_add_u32 s48, s48, s46
    s_add_u32 m0, s44, 81920
    s_add_u32 s47, s48, 0
    buffer_load_dwordx4 v5, s[32:35], s47 offen lds
    s_add_u32 m0, s44, 82944
    s_add_u32 s47, s48, 64
    buffer_load_dwordx4 v5, s[32:35], s47 offen lds
    s_add_u32 m0, s44, 83968
    s_add_u32 s47, s48, 128
    buffer_load_dwordx4 v5, s[32:35], s47 offen lds
    s_add_u32 m0, s44, 84992
    s_add_u32 s47, s48, 192
    buffer_load_dwordx4 v5, s[32:35], s47 offen lds
    s_add_u32 m0, s60, -36
    s_mov_b64 exec, 1
    buffer_load_dword v9, s[20:23], s61 offen offset:36 lds
    s_mov_b64 exec, -1
    s_waitcnt vmcnt(12)
    s_barrier
    s_add_u32 s48, s42, 6
    s_and_b32 s48, s48, 7
    s_mul_i32 s48, s48, 229376
    s_add_u32 s48, s48, s46
    s_add_u32 m0, s44, 98304
    s_add_u32 s47, s48, 0
    buffer_load_dwordx4 v5, s[32:35], s47 offen lds
    s_add_u32 m0, s44, 99328
    s_add_u32 s47, s48, 64
    buffer_load_dwordx4 v5, s[32:35], s47 offen lds
    s_add_u32 m0, s44, 100352
    s_add_u32 s47, s48, 128
    buffer_load_dwordx4 v5, s[32:35], s47 offen lds
    s_add_u32 m0, s44, 101376
    s_add_u32 s47, s48, 192
    buffer_load_dwordx4 v5, s[32:35], s47 offen lds
    s_add_u32 m0, s60, -40
    s_mov_b64 exec, 1
    buffer_load_dword v9, s[20:23], s61 offen offset:40 lds
    s_mov_b64 exec, -1
    s_waitcnt vmcnt(10)
    s_barrier
    s_add_u32 s48, s42, 5
    s_and_b32 s48, s48, 7
    s_mul_i32 s48, s48, 229376
    s_add_u32 s48, s48, s46
    s_add_u32 m0, s44, 114688
    s_add_u32 s47, s48, 0
    buffer_load_dwordx4 v5, s[32:35], s47 offen lds
    s_add_u32 m0, s44, 115712
    s_add_u32 s47, s48, 64
    buffer_load_dwordx4 v5, s[32:35], s47 offen lds
    s_add_u32 m0, s44, 116736
    s_add_u32 s47, s48, 128
    buffer_load_dwordx4 v5, s[32:35], s47 offen lds
    s_add_u32 m0, s44, 117760
    s_add_u32 s47, s48, 192
    buffer_load_dwordx4 v5, s[32:35], s47 offen lds
    s_add_u32 m0, s60, -44
    s_mov_b64 exec, 1
    buffer_load_dword v9, s[20:23], s61 offen offset:44 lds
    s_mov_b64 exec, -1
L_fr11:
    ds_read_b32 v13, v10 offset:0
    s_waitcnt lgkmcnt(0)
    v_cmp_gt_u32 vcc, 8, v13
    s_nop 0
    s_cbranch_vccz L_fr11_ok
    s_sleep 1
    s_branch L_fr11
L_fr11_ok:
    s_add_u32 s48, s42, 4
    s_and_b32 s48, s48, 7
    s_mul_i32 s48, s48, 229376
    s_add_u32 s48, s48, s46
    s_add_u32 m0, s44, 131072
    s_add_u32 s47, s48, 0
    buffer_load_dwordx4 v5, s[32:35], s47 offen lds
    s_add_u32 m0, s44, 132096
    s_add_u32 s47, s48, 64
    buffer_load_dwordx4 v5, s[32:35], s47 offen lds
    s_add_u32 m0, s44, 133120
    s_add_u32 s47, s48, 128
    buffer_load_dwordx4 v5, s[32:35], s47 offen lds
    s_add_u32 m0, s44, 134144
    s_add_u32 s47, s48, 192
    buffer_load_dwordx4 v5, s[32:35], s47 offen lds
    s_add_u32 m0, s60, -48
    s_mov_b64 exec, 1
    buffer_load_dword v9, s[20:23], s61 offen offset:48 lds
    s_mov_b64 exec, -1
L_fr12:
    ds_read_b32 v13, v10 offset:0
    s_waitcnt lgkmcnt(0)
    v_cmp_gt_u32 vcc, 9, v13
    s_nop 0
    s_cbranch_vccz L_fr12_ok
    s_sleep 1
    s_branch L_fr12
L_fr12_ok:
    s_add_u32 s48, s42, 3
    s_and_b32 s48, s48, 7
    s_mul_i32 s48, s48, 229376
    s_add_u32 s48, s48, s46
    s_add_u32 m0, s44, 81920
    s_add_u32 s47, s48, 0
    buffer_load_dwordx4 v5, s[32:35], s47 offen lds
    s_add_u32 m0, s44, 82944
    s_add_u32 s47, s48, 64
    buffer_load_dwordx4 v5, s[32:35], s47 offen lds
    s_add_u32 m0, s44, 83968
    s_add_u32 s47, s48, 128
    buffer_load_dwordx4 v5, s[32:35], s47 offen lds
    s_add_u32 m0, s44, 84992
    s_add_u32 s47, s48, 192
    buffer_load_dwordx4 v5, s[32:35], s47 offen lds
    s_add_u32 m0, s60, -52
    s_mov_b64 exec, 1
    buffer_load_dword v9, s[20:23], s61 offen offset:52 lds
    s_mov_b64 exec, -1
L_fr13:
    ds_read_b32 v13, v10 offset:0
    s_waitcnt lgkmcnt(0)
    v_cmp_gt_u32 vcc, 10, v13
    s_nop 0
    s_cbranch_vccz L_fr13_ok
    s_sleep 1
    s_branch L_fr13
L_fr13_ok:
    s_add_u32 s48, s42, 2
    s_and_b32 s48, s48, 7
    s_mul_i32 s48, s48, 229376
    s_add_u32 s48, s48, s46
    s_add_u32 m0, s44, 98304
    s_add_u32 s47, s48, 0
    buffer_load_dwordx4 v5, s[32:35], s47 offen lds
    s_add_u32 m0, s44, 99328
    s_add_u32 s47, s48, 64
    buffer_load_dwordx4 v5, s[32:35], s47 offen lds
    s_add_u32 m0, s44, 100352
    s_add_u32 s47, s48, 128
    buffer_load_dwordx4 v5, s[32:35], s47 offen lds
    s_add_u32 m0, s44, 101376
    s_add_u32 s47, s48, 192
    buffer_load_dwordx4 v5, s[32:35], s47 offen lds
    s_add_u32 s48, s42, 2
    s_and_b32 s48, s48, 7
    s_mul_i32 s48, s48, 128
    s_add_u32 s48, s48, s43
    s_add_u32 m0, s44, 32768
    s_add_u32 s47, s48, 0
    buffer_load_dwordx4 v2, s[24:27], s47 offen lds
    s_add_u32 m0, s44, 33792
    s_add_u32 s47, s48, 8192
    buffer_load_dwordx4 v3, s[24:27], s47 offen lds
    s_add_u32 m0, s44, 34816
    s_add_u32 s47, s48, 16384
    buffer_load_dwordx4 v2, s[24:27], s47 offen lds
    s_add_u32 m0, s44, 35840
    s_add_u32 s47, s48, 24576
    buffer_load_dwordx4 v3, s[24:27], s47 offen lds
    s_add_u32 m0, s60, -56
    s_mov_b64 exec, 1
    buffer_load_dword v9, s[20:23], s61 offen offset:56 lds
    s_mov_b64 exec, -1
L_fr14:
    ds_read_b32 v13, v10 offset:0
    s_waitcnt lgkmcnt(0)
    v_cmp_gt_u32 vcc, 11, v13
    s_nop 0
    s_cbranch_vccz L_fr14_ok
    s_sleep 1
    s_branch L_fr14
L_fr14_ok:
    s_add_u32 s48, s42, 1
    s_and_b32 s48, s48, 7
    s_mul_i32 s48, s48, 229376
    s_add_u32 s48, s48, s46
    s_add_u32 m0, s44, 114688
    s_add_u32 s47, s48, 0
    buffer_load_dwordx4 v5, s[32:35], s47 offen lds
    s_add_u32 m0, s44, 115712
    s_add_u32 s47, s48, 64
    buffer_load_dwordx4 v5, s[32:35], s47 offen lds
    s_add_u32 m0, s44, 116736
    s_add_u32 s47, s48, 128
    buffer_load_dwordx4 v5, s[32:35], s47 offen lds
    s_add_u32 m0, s44, 117760
    s_add_u32 s47, s48, 192
    buffer_load_dwordx4 v5, s[32:35], s47 offen lds
    s_add_u32 s48, s42, 1
    s_and_b32 s48, s48, 7
    s_mul_i32 s48, s48, 128
    s_add_u32 s48, s48, s43
    s_add_u32 m0, s44, 16384
    s_add_u32 s47, s48, 0
    buffer_load_dwordx4 v2, s[24:27], s47 offen lds
    s_add_u32 m0, s44, 17408
    s_add_u32 s47, s48, 8192
    buffer_load_dwordx4 v3, s[24:27], s47 offen lds
    s_add_u32 m0, s44, 18432
    s_add_u32 s47, s48, 16384
    buffer_load_dwordx4 v2, s[24:27], s47 offen lds
    s_add_u32 m0, s44, 19456
    s_add_u32 s47, s48, 24576
    buffer_load_dwordx4 v3, s[24:27], s47 offen lds
    s_add_u32 m0, s60, -60
    s_mov_b64 exec, 1
    buffer_load_dword v9, s[20:23], s61 offen offset:60 lds
    s_mov_b64 exec, -1
L_fr15:
    ds_read_b32 v13, v10 offset:0
    s_waitcnt lgkmcnt(0)
    v_cmp_gt_u32 vcc, 12, v13
    s_nop 0
    s_cbranch_vccz L_fr15_ok
    s_sleep 1
    s_branch L_fr15
L_fr15_ok:
    s_add_u32 s48, s42, 0
    s_and_b32 s48, s48, 7
    s_mul_i32 s48, s48, 229376
    s_add_u32 s48, s48, s46
    s_add_u32 m0, s44, 131072
    s_add_u32 s47, s48, 0
    buffer_load_dwordx4 v5, s[32:35], s47 offen lds
    s_add_u32 m0, s44, 132096
    s_add_u32 s47, s48, 64
    buffer_load_dwordx4 v5, s[32:35], s47 offen lds
    s_add_u32 m0, s44, 133120
    s_add_u32 s47, s48, 128
    buffer_load_dwordx4 v5, s[32:35], s47 offen lds
    s_add_u32 m0, s44, 134144
    s_add_u32 s47, s48, 192
    buffer_load_dwordx4 v5, s[32:35], s47 offen lds
    s_add_u32 s48, s42, 0
    s_and_b32 s48, s48, 7
    s_mul_i32 s48, s48, 128
    s_add_u32 s48, s48, s43
    s_add_u32 m0, s44, 0
    s_add_u32 s47, s48, 0
    buffer_load_dwordx4 v2, s[24:27], s47 offen lds
    s_add_u32 m0, s44, 1024
    s_add_u32 s47, s48, 8192
    buffer_load_dwordx4 v3, s[24:27], s47 offen lds
    s_add_u32 m0, s44, 2048
    s_add_u32 s47, s48, 16384
    buffer_load_dwordx4 v2, s[24:27], s47 offen lds
    s_add_u32 m0, s44, 3072
    s_add_u32 s47, s48, 24576
    buffer_load_dwordx4 v3, s[24:27], s47 offen lds
    s_add_u32 m0, s60, -64
    s_mov_b64 exec, 1
    buffer_load_dword v9, s[20:23], s61 offen offset:64 lds
    s_mov_b64 exec, -1
    s_branch L_load_idle
L_idle_bar:
    s_waitcnt vmcnt(7)
    s_barrier
    s_waitcnt vmcnt(0)
    s_barrier
L_load_idle:
    s_waitcnt lgkmcnt(0)
    s_add_u32 s18, s18, 1
    s_add_u32 s19, s19, 1
    s_lshl_b32 s51, s40, 3
    s_add_u32 s51, s51, s41
    s_lshl_b32 s51, s51, 9
    s_add_u32 s50, s51, 65536
    s_lshr_b32 s52, s39, 1
    s_lshl_b32 s53, s52, 21
    s_lshl_b32 s54, s40, 16
    s_add_u32 s53, s53, s54
    s_and_b32 s55, s39, 1
    s_lshl_b32 s54, s55, 15
    s_add_u32 s53, s53, s54
    s_add_u32 s53, s53, 3145728
    s_lshl_b32 s54, s52, 10
    s_sub_u32 s54, s53, s54
    s_lshl_b32 s55, s39, 11
    s_cmp_eq_u32 s39, 3
    s_cselect_b32 s55, 5120, s55
    v_mov_b32 v15, 150588
L_fr12b:
    ds_read_b32 v13, v10 offset:0
    s_waitcnt lgkmcnt(0)
    v_cmp_gt_u32 vcc, 12, v13
    s_nop 0
    s_cbranch_vccz L_fr12b_ok
    s_sleep 1
    s_branch L_fr12b
L_fr12b_ok:
L_go1:
    ds_read_b32 v14, v15 offset:0
    s_waitcnt lgkmcnt(0)
    v_cmp_gt_u32 vcc, 1, v14
    s_nop 0
    s_cbranch_vccz L_go1_ok
    s_sleep 1
    s_branch L_go1
L_go1_ok:
    s_setprio 3
    s_add_u32 m0, s55, 150784
    s_cmp_ge_u32 s39, 2
    buffer_load_dwordx4 v1, s[20:23], s53 offen sc1 lds
    s_cbranch_scc1 L_pv
    buffer_load_dwordx4 v1, s[20:23], s53 offen offset:1024 sc1 lds
L_pv:
    s_add_u32 m0, s44, 65536
    s_add_u32 s47, s54, 2048
    buffer_load_dwordx4 v1, s[20:23], s47 offen offset:0 sc1 lds
    buffer_load_dwordx4 v1, s[20:23], s47 offen offset:1024 sc1 lds
    buffer_load_dwordx4 v1, s[20:23], s47 offen offset:2048 sc1 lds
    buffer_load_dwordx4 v1, s[20:23], s47 offen offset:3072 sc1 lds
    s_add_u32 m0, s60, 60
    s_mov_b64 exec, 1
    buffer_load_dword v9, s[20:23], s61 offen offset:4 lds
    s_mov_b64 exec, -1
    s_cmp_lg_u32 s39, 0
    s_cbranch_scc1 L_pq2_f
    s_mov_b32 s58, 200000
    s_mov_b32 exec_hi, 0xffff
L_pq2:
    buffer_load_dwordx2 v[16:17], v6, s[20:23], s50 offen sc1
    s_waitcnt vmcnt(0)
    v_xor_b32 v16, s18, v16
    v_xor_b32 v17, s19, v17
    v_or_b32 v16, v16, v17
    v_cmp_ne_u32 vcc, 0, v16
    s_sub_u32 s58, s58, 1
    s_cbranch_scc1 L_pq2_ok
    s_cbranch_vccz L_pq2_ok
    s_sleep 8
    s_branch L_pq2
L_pq2_ok:
    s_mov_b64 exec, -1
    v_mov_b32 v14, 2
    ds_write_b32 v15, v14
    s_branch L_pq2_fw_ok
L_pq2_f:
L_pq2_fw:
    ds_read_b32 v14, v15 offset:0
    s_waitcnt lgkmcnt(0)
    v_cmp_gt_u32 vcc, 2, v14
    s_nop 0
    s_cbranch_vccz L_pq2_fw_ok
    s_sleep 1
    s_branch L_pq2_fw
L_pq2_fw_ok:
L_fr14b:
    ds_read_b32 v13, v10 offset:0
    s_waitcnt lgkmcnt(0)
    v_cmp_gt_u32 vcc, 14, v13
    s_nop 0
    s_cbranch_vccz L_fr14b_ok
    s_sleep 1
    s_branch L_fr14b
L_fr14b_ok:
    s_add_u32 m0, s44, 49152
    s_add_u32 s47, s54, 6144
    s_waitcnt vmcnt(1)
    buffer_load_dwordx4 v1, s[20:23], s47 offen offset:0 sc1 lds
    s_waitcnt vmcnt(1)
    buffer_load_dwordx4 v1, s[20:23], s47 offen offset:1024 sc1 lds
    s_waitcnt vmcnt(1)
    buffer_load_dwordx4 v1, s[20:23], s47 offen offset:2048 sc1 lds
    s_waitcnt vmcnt(1)
    buffer_load_dwordx4 v1, s[20:23], s47 offen offset:3072 sc1 lds
    s_add_u32 m0, s60, 56
    s_mov_b64 exec, 1
    buffer_load_dword v9, s[20:23], s61 offen offset:8 lds
    s_mov_b64 exec, -1
    s_add_u32 m0, s44, 81920
    s_add_u32 s47, s54, 10240
    s_waitcnt vmcnt(1)
    buffer_load_dwordx4 v1, s[20:23], s47 offen offset:0 sc1 lds
    s_waitcnt vmcnt(1)
    buffer_load_dwordx4 v1, s[20:23], s47 offen offset:1024 sc1 lds
    s_waitcnt vmcnt(1)
    buffer_load_dwordx4 v1, s[20:23], s47 offen offset:2048 sc1 lds
    s_waitcnt vmcnt(1)
    buffer_load_dwordx4 v1, s[20:23], s47 offen offset:3072 sc1 lds
    s_add_u32 m0, s60, 52
    s_mov_b64 exec, 1
    buffer_load_dword v9, s[20:23], s61 offen offset:12 lds
    s_mov_b64 exec, -1
    s_add_u32 m0, s44, 32768
    s_add_u32 s47, s54, 14336
    s_waitcnt vmcnt(1)
    buffer_load_dwordx4 v1, s[20:23], s47 offen offset:0 sc1 lds
    s_waitcnt vmcnt(1)
    buffer_load_dwordx4 v1, s[20:23], s47 offen offset:1024 sc1 lds
    s_waitcnt vmcnt(1)
    buffer_load_dwordx4 v1, s[20:23], s47 offen offset:2048 sc1 lds
    s_waitcnt vmcnt(1)
    buffer_load_dwordx4 v1, s[20:23], s47 offen offset:3072 sc1 lds
    s_add_u32 m0, s44, 98304
    s_add_u32 s47, s54, 18432
    s_waitcnt vmcnt(1)
    buffer_load_dwordx4 v1, s[20:23], s47 offen offset:0 sc1 lds
    s_waitcnt vmcnt(1)
    buffer_load_dwordx4 v1, s[20:23], s47 offen offset:1024 sc1 lds
    s_waitcnt vmcnt(1)
    buffer_load_dwordx4 v1, s[20:23], s47 offen offset:2048 sc1 lds
    s_waitcnt vmcnt(1)
    buffer_load_dwordx4 v1, s[20:23], s47 offen offset:3072 sc1 lds
    s_add_u32 m0, s60, 44
    s_mov_b64 exec, 1
    buffer_load_dword v9, s[20:23], s61 offen offset:20 lds
    s_mov_b64 exec, -1
    s_mov_b32 s28, s14
    s_mov_b32 s29, s15
    s_mov_b32 s30, 0x1c0000
    s_mov_b32 s31, 0x20000
    s_mov_b32 s32, s8
    s_mov_b32 s33, s9
    s_mov_b32 s34, 0x80000
    s_mov_b32 s35, 0x20000
    v_lshl_add_u32 v14, v7, 10, v8
    s_mul_i32 s56, s37, 7
    s_lshl_b32 s57, s39, 1
    s_add_u32 s56, s56, s57
    s_lshl_b32 s58, s36, 6
    s_lshl_b32 s48, s56, 14
    s_add_u32 s48, s48, s58
    s_mul_i32 s49, s36, 112
    s_add_u32 s56, s56, s49
    s_lshl_b32 s56, s56, 10
    s_add_u32 s56, s56, 16777216
    s_lshl_b32 s49, s37, 15
    s_add_u32 s49, s49, s58
    s_lshl_b32 s58, s36, 4
    s_add_u32 s58, s58, s37
    s_lshl_b32 s58, s58, 11
    s_add_u32 s58, s58, 18874368
    s_lshl_b32 s57, s57, 10
L_fr17:
    ds_read_b32 v13, v10 offset:0
    s_waitcnt lgkmcnt(0)
    v_cmp_gt_u32 vcc, 17, v13
    s_nop 0
    s_cbranch_vccz L_fr17_ok
    s_sleep 1
    s_branch L_fr17
L_fr17_ok:
    s_add_u32 m0, s57, 131072
    s_cmp_eq_u32 s39, 3
    buffer_load_dwordx4 v14, s[28:31], s48 offen lds
    s_cbranch_scc1 L_rl_w3
    s_add_u32 m0, s57, 132096
    s_add_u32 s48, s48, 16384
    buffer_load_dwordx4 v14, s[28:31], s48 offen lds
    s_add_u32 s59, s56, 1024
    s_branch L_rl_w
L_rl_w3:
    s_add_u32 m0, s57, 132096
    s_mov_b32 s59, s58
    buffer_load_dwordx4 v14, s[32:35], s49 offen lds
    s_mov_b32 m0, 139264
    s_add_u32 s49, s49, 16384
    buffer_load_dwordx4 v14, s[32:35], s49 offen lds
L_rl_w:
    s_add_u32 m0, s44, 16384
    s_add_u32 s47, s54, 22528
    s_waitcnt vmcnt(1)
    buffer_load_dwordx4 v1, s[20:23], s47 offen offset:0 sc1 lds
    s_waitcnt vmcnt(1)
    buffer_load_dwordx4 v1, s[20:23], s47 offen offset:1024 sc1 lds
    s_waitcnt vmcnt(1)
    buffer_load_dwordx4 v1, s[20:23], s47 offen offset:2048 sc1 lds
    s_waitcnt vmcnt(1)
    buffer_load_dwordx4 v1, s[20:23], s47 offen offset:3072 sc1 lds
    s_add_u32 m0, s44, 114688
    s_add_u32 s47, s54, 26624
    s_waitcnt vmcnt(1)
    buffer_load_dwordx4 v1, s[20:23], s47 offen offset:0 sc1 lds
    s_waitcnt vmcnt(1)
    buffer_load_dwordx4 v1, s[20:23], s47 offen offset:1024 sc1 lds
    s_waitcnt vmcnt(1)
    buffer_load_dwordx4 v1, s[20:23], s47 offen offset:2048 sc1 lds
    s_waitcnt vmcnt(1)
    buffer_load_dwordx4 v1, s[20:23], s47 offen offset:3072 sc1 lds
    s_add_u32 m0, s44, 0
    s_add_u32 s47, s54, 30720
    s_waitcnt vmcnt(1)
    buffer_load_dwordx4 v1, s[20:23], s47 offen offset:0 sc1 lds
    s_waitcnt vmcnt(1)
    buffer_load_dwordx4 v1, s[20:23], s47 offen offset:1024 sc1 lds
    s_cmp_lt_u32 s39, 2
    s_cbranch_scc1 L_w7
    buffer_load_dwordx4 v1, s[20:23], s47 offen offset:2048 sc1 lds
L_w7:
    s_add_u32 m0, s60, 32
    s_mov_b64 exec, 1
    buffer_load_dword v9, s[20:23], s61 offen offset:32 lds
    s_mov_b64 exec, -1
    v_lshrrev_b32 v7, 5, v0
    v_bfe_u32 v9, v0, 2, 2
    v_lshl_add_u32 v7, v7, 2, v9
    v_lshlrev_b32 v7, 6, v7
    v_bfe_u32 v9, v0, 4, 1
    v_lshl_add_u32 v7, v9, 5, v7
    v_and_b32 v9, 3, v0
    v_lshl_add_u32 v14, v9, 3, v7
    s_lshr_b32 s43, s39, 1
    s_and_b32 s44, s39, 1
    s_add_u32 s57, s57, 131072
    v_add_u32 v14, s57, v14
    v_mov_b32 v2, 150528
    s_waitcnt vmcnt(11)
    ds_read_b64_tr_b16 v[16:17], v14 offset:0
    ds_read_b64_tr_b16 v[18:19], v14 offset:512
    ds_read_b64_tr_b16 v[20:21], v14 offset:1024
    ds_read_b64_tr_b16 v[22:23], v14 offset:1536
    ds_read_b64_tr_b16 v[24:25], v14 offset:2048
    ds_read_b64_tr_b16 v[26:27], v14 offset:2560
    s_waitcnt lgkmcnt(0)
    buffer_store_dwordx4 v[16:19], v1, s[20:23], s56 offen sc1
    buffer_store_dwordx4 v[20:23], v1, s[20:23], s59 offen sc1
    s_cmp_lg_u32 s39, 3
    s_cbranch_scc1 L_rl_s3
    buffer_store_dwordx4 v[24:27], v1, s[20:23], s58 offen offset:1024 sc1
L_rl_s3:
    v_min_u32 v7, 13, v0
    v_cmp_gt_u32 vcc, 16, v0
    s_add_u32 s50, s51, 196608
    s_mul_i32 s47, s39, 28
    v_cndmask_b32 v6, v0, v7, vcc
    v_lshlrev_b32 v6, 3, v6
    s_lshl_b32 s52, s41, 1
    s_add_u32 s52, s52, s43
    s_xor_b32 s53, s52, 1
    s_lshl_b32 s54, s40, 1
    s_add_u32 s54, s54, s44
    s_xor_b32 s55, s54, 1
    s_mul_i32 s52, s52, 112
    s_add_u32 s52, s52, s47
    s_lshl_b32 s52, s52, 10
    s_add_u32 s52, s52, 16777216
    s_mul_i32 s53, s53, 112
    s_add_u32 s53, s53, s47
    s_lshl_b32 s53, s53, 10
    s_add_u32 s53, s53, 16777216
    s_mul_i32 s54, s54, 112
    s_add_u32 s54, s54, s47
    s_lshl_b32 s54, s54, 10
    s_add_u32 s54, s54, 7340032
    s_mul_i32 s55, s55, 112
    s_add_u32 s55, s55, s47
    s_lshl_b32 s55, s55, 10
    s_add_u32 s55, s55, 7340032
    s_waitcnt vmcnt(0)
    v_mov_b32 v8, 1
    s_mov_b64 exec, 1
    ds_add_rtn_u32 v8, v2, v8 offset:52
    s_mov_b64 exec, -1
    s_lshr_b32 s48, s36, 1
    s_lshl_b32 s48, s48, 9
    s_and_b32 s49, s36, 1
    s_add_u32 s49, s49, 1
    s_lshl_b32 s49, s49, 7
    s_add_u32 s48, s48, s49
    v_lshl_add_u32 v10, v0, 12, s48
    s_lshl_b32 s48, s36, 13
    v_and_b32 v9, 15, v0
    v_cmp_gt_u32 vcc, 32, v0
    v_lshl_add_u32 v9, v9, 9, s48
    s_lshl_b32 s48, s37, 3
    v_cndmask_b32 v10, v9, v10, vcc
    v_add_u32 v10, s48, v10
    s_waitcnt lgkmcnt(0)
    v_readfirstlane_b32 s49, v8
    s_nop 0
    s_cmp_lg_u32 s49, 11
    s_cbranch_scc1 L_f2f
    v_mov_b32 v8, s18
    v_mov_b32 v9, s19
    s_mov_b32 s48, 196608
    s_mov_b32 exec_hi, 0xffff
    buffer_store_dwordx2 v[8:9], v10, s[20:23], s48 offen sc1
    s_mov_b64 exec, -1
L_f2f:
    v_mov_b32 v2, 150576
    v_mov_b32 v3, 1
    s_cmp_lg_u32 s39, 0
    s_cbranch_scc1 L_pf2_f
    s_mov_b32 s58, 200000
    s_mov_b32 exec_hi, 0xffff
L_pf2:
    buffer_load_dwordx2 v[16:17], v6, s[20:23], s50 offen sc1
    s_waitcnt vmcnt(0)
    v_xor_b32 v16, s18, v16
    v_xor_b32 v17, s19, v17
    v_or_b32 v16, v16, v17
    v_cmp_ne_u32 vcc, 0, v16
    s_sub_u32 s58, s58, 1
    s_cbranch_scc1 L_pf2_ok
    s_cbranch_vccz L_pf2_ok
    s_sleep 8
    s_branch L_pf2
L_pf2_ok:
    s_mov_b64 exec, -1
    v_mov_b32 v14, 3
    ds_write_b32 v15, v14
    s_branch L_pf2_fw_ok
L_pf2_f:
L_pf2_fw:
    ds_read_b32 v14, v15 offset:0
    s_waitcnt lgkmcnt(0)
    v_cmp_gt_u32 vcc, 3, v14
    s_nop 0
    s_cbranch_vccz L_pf2_fw_ok
    s_sleep 8
    s_branch L_pf2_fw
L_pf2_fw_ok:
    s_setprio 0
    buffer_load_dwordx4 v[72:75], v1, s[20:23], s52 offen offset:0 sc1
    buffer_load_dwordx4 v[76:79], v1, s[20:23], s53 offen offset:0 sc1
    buffer_load_dwordx4 v[80:83], v1, s[20:23], s54 offen offset:0 sc1
    buffer_load_dwordx4 v[84:87], v1, s[20:23], s55 offen offset:0 sc1
    buffer_load_dwordx4 v[88:91], v1, s[20:23], s52 offen offset:1024 sc1
    buffer_load_dwordx4 v[92:95], v1, s[20:23], s53 offen offset:1024 sc1
    buffer_load_dwordx4 v[96:99], v1, s[20:23], s54 offen offset:1024 sc1
    buffer_load_dwordx4 v[100:103], v1, s[20:23], s55 offen offset:1024 sc1
    buffer_load_dwordx4 v[104:107], v1, s[20:23], s52 offen offset:2048 sc1
    buffer_load_dwordx4 v[108:111], v1, s[20:23], s53 offen offset:2048 sc1
    buffer_load_dwordx4 v[112:115], v1, s[20:23], s54 offen offset:2048 sc1
    buffer_load_dwordx4 v[116:119], v1, s[20:23], s55 offen offset:2048 sc1
    buffer_load_dwordx4 v[120:123], v1, s[20:23], s52 offen offset:3072 sc1
    buffer_load_dwordx4 v[124:127], v1, s[20:23], s53 offen offset:3072 sc1
    buffer_load_dwordx4 v[128:131], v1, s[20:23], s54 offen offset:3072 sc1
    buffer_load_dwordx4 v[132:135], v1, s[20:23], s55 offen offset:3072 sc1
    v_mov_b32 v4, 0
    v_mov_b32 v5, 0
    v_mov_b32 v6, 0
    v_mov_b32 v7, 0
    s_mov_b32 s47, 6
    s_nop 0
    v_mfma_f32_32x32x16_bf16 v[8:23], v[4:7], v[4:7], 0
    v_mfma_f32_32x32x16_bf16 v[24:39], v[4:7], v[4:7], 0
    v_mfma_f32_32x32x16_bf16 v[40:55], v[4:7], v[4:7], 0
    v_mfma_f32_32x32x16_bf16 v[56:71], v[4:7], v[4:7], 0
L_floop:
    s_add_u32 s52, s52, 4096
    s_add_u32 s53, s53, 4096
    s_add_u32 s54, s54, 4096
    s_add_u32 s55, s55, 4096
    s_waitcnt vmcnt(12)
    v_mfma_f32_32x32x16_bf16 v[8:23], v[72:75], v[80:83], v[8:23]
    v_mfma_f32_32x32x16_bf16 v[24:39], v[72:75], v[84:87], v[24:39]
    v_mfma_f32_32x32x16_bf16 v[40:55], v[76:79], v[80:83], v[40:55]
    v_mfma_f32_32x32x16_bf16 v[56:71], v[76:79], v[84:87], v[56:71]
    buffer_load_dwordx4 v[72:75], v1, s[20:23], s52 offen offset:0 sc1
    buffer_load_dwordx4 v[76:79], v1, s[20:23], s53 offen offset:0 sc1
    buffer_load_dwordx4 v[80:83], v1, s[20:23], s54 offen offset:0 sc1
    buffer_load_dwordx4 v[84:87], v1, s[20:23], s55 offen offset:0 sc1
    s_waitcnt vmcnt(12)
    v_mfma_f32_32x32x16_bf16 v[8:23], v[88:91], v[96:99], v[8:23]
    v_mfma_f32_32x32x16_bf16 v[24:39], v[88:91], v[100:103], v[24:39]
    v_mfma_f32_32x32x16_bf16 v[40:55], v[92:95], v[96:99], v[40:55]
    v_mfma_f32_32x32x16_bf16 v[56:71], v[92:95], v[100:103], v[56:71]
    buffer_load_dwordx4 v[88:91], v1, s[20:23], s52 offen offset:1024 sc1
    buffer_load_dwordx4 v[92:95], v1, s[20:23], s53 offen offset:1024 sc1
    buffer_load_dwordx4 v[96:99], v1, s[20:23], s54 offen offset:1024 sc1
    buffer_load_dwordx4 v[100:103], v1, s[20:23], s55 offen offset:1024 sc1
    s_waitcnt vmcnt(12)
    v_mfma_f32_32x32x16_bf16 v[8:23], v[104:107], v[112:115], v[8:23]
    v_mfma_f32_32x32x16_bf16 v[24:39], v[104:107], v[116:119], v[24:39]
    v_mfma_f32_32x32x16_bf16 v[40:55], v[108:111], v[112:115], v[40:55]
    v_mfma_f32_32x32x16_bf16 v[56:71], v[108:111], v[116:119], v[56:71]
    buffer_load_dwordx4 v[104:107], v1, s[20:23], s52 offen offset:2048 sc1
    buffer_load_dwordx4 v[108:111], v1, s[20:23], s53 offen offset:2048 sc1
    buffer_load_dwordx4 v[112:115], v1, s[20:23], s54 offen offset:2048 sc1
    buffer_load_dwordx4 v[116:119], v1, s[20:23], s55 offen offset:2048 sc1
    s_waitcnt vmcnt(12)
    v_mfma_f32_32x32x16_bf16 v[8:23], v[120:123], v[128:131], v[8:23]
    v_mfma_f32_32x32x16_bf16 v[24:39], v[120:123], v[132:135], v[24:39]
    v_mfma_f32_32x32x16_bf16 v[40:55], v[124:127], v[128:131], v[40:55]
    v_mfma_f32_32x32x16_bf16 v[56:71], v[124:127], v[132:135], v[56:71]
    buffer_load_dwordx4 v[120:123], v1, s[20:23], s52 offen offset:3072 sc1
    buffer_load_dwordx4 v[124:127], v1, s[20:23], s53 offen offset:3072 sc1
    buffer_load_dwordx4 v[128:131], v1, s[20:23], s54 offen offset:3072 sc1
    buffer_load_dwordx4 v[132:135], v1, s[20:23], s55 offen offset:3072 sc1
    s_sub_u32 s47, s47, 1
    s_cmp_lg_u32 s47, 0
    s_cbranch_scc1 L_floop
    s_mov_b32 s28, s4
    s_mov_b32 s29, s5
    s_mov_b32 s30, 0x200000
    s_mov_b32 s31, 0x20000
    s_mov_b32 s24, s16
    s_mov_b32 s25, s17
    s_mov_b32 s26, 0x200000
    s_mov_b32 s27, 0x20000
    s_setprio 3
    s_lshl_b32 s51, s40, 1
    s_add_u32 s51, s51, s44
    s_lshl_b32 s47, s51, 7
    s_add_u32 s47, s47, 524288
    v_and_b32 v7, 31, v0
    v_lshlrev_b32 v6, 2, v7
    buffer_load_dword v144, v6, s[20:23], s47 offen sc1
    s_lshl_b32 s51, s51, 15
    s_lshl_b32 s47, s41, 1
    s_add_u32 s47, s47, s43
    s_lshl_b32 s47, s47, 6
    s_add_u32 s51, s51, s47
    s_add_u32 s52, s51, 16384
    v_lshrrev_b32 v4, 2, v0
    v_and_b32 v5, 3, v0
    v_lshlrev_b32 v5, 4, v5
    v_lshl_add_u32 v6, v4, 10, v5
    buffer_load_dwordx4 v[136:139], v6, s[28:31], s51 offen
    buffer_load_dwordx4 v[140:143], v6, s[28:31], s52 offen
    s_mul_i32 s47, s39, 2560
    s_add_u32 s47, s47, 131072
    v_mul_u32_u24 v4, 80, v4
    v_add3_u32 v161, v4, v5, s47
    v_mul_u32_u24 v4, 80, v7
    v_lshrrev_b32 v5, 5, v0
    v_lshl_add_u32 v4, v5, 3, v4
    v_add_u32 v160, s47, v4
    s_mul_i32 s47, s44, 98304
    v_add_u32 v162, s47, v1
    s_lshl_b32 s47, s43, 15
    s_add_u32 s47, s47, 32768
    v_add_u32 v163, s47, v1
    s_lshl_b32 s53, s41, 16
    s_lshl_b32 s54, s39, 14
    s_add_u32 s53, s53, s54
    s_add_u32 s53, s53, 18874368
    s_add_u32 s54, s54, 32768
    v_lshlrev_b32 v7, 3, v0
    s_lshl_b32 s50, s40, 3
    s_add_u32 s50, s50, s41
    s_lshl_b32 s50, s50, 2
    s_add_u32 s50, s50, s39
    s_lshl_b32 s50, s50, 7
    s_add_u32 s50, s50, 327680
    s_lshl_b32 s55, s40, 16
    s_lshl_b32 s49, s39, 10
    s_add_u32 s55, s55, s49
    s_lshl_b32 s49, s39, 10
    s_add_u32 s55, s55, 14680064
    v_and_b32 v5, 7, v0
    v_lshlrev_b32 v5, 2, v5
    v_add_u32 v5, 150544, v5
    s_movk_i32 s48, 200
L_xfree:
    ds_read_b32 v145, v5 offset:0
    s_waitcnt lgkmcnt(0)
    v_cmp_gt_u32 vcc, s48, v145
    s_nop 0
    s_cbranch_vccz L_xfree_ok
    s_sleep 8
    s_branch L_xfree
L_xfree_ok:
    s_add_u32 m0, s54, 0
    s_add_u32 s48, s53, 0
    buffer_load_dwordx4 v1, s[20:23], s48 offen offset:0 sc1 lds
    buffer_load_dwordx4 v1, s[20:23], s48 offen offset:1024 sc1 lds
    buffer_load_dwordx4 v1, s[20:23], s48 offen offset:2048 sc1 lds
    buffer_load_dwordx4 v1, s[20:23], s48 offen offset:3072 sc1 lds
    s_add_u32 m0, s54, 4096
    s_add_u32 s48, s53, 4096
    buffer_load_dwordx4 v1, s[20:23], s48 offen offset:0 sc1 lds
    buffer_load_dwordx4 v1, s[20:23], s48 offen offset:1024 sc1 lds
    buffer_load_dwordx4 v1, s[20:23], s48 offen offset:2048 sc1 lds
    buffer_load_dwordx4 v1, s[20:23], s48 offen offset:3072 sc1 lds
    s_add_u32 m0, s54, 8192
    s_add_u32 s48, s53, 8192
    buffer_load_dwordx4 v1, s[20:23], s48 offen offset:0 sc1 lds
    buffer_load_dwordx4 v1, s[20:23], s48 offen offset:1024 sc1 lds
    buffer_load_dwordx4 v1, s[20:23], s48 offen offset:2048 sc1 lds
    buffer_load_dwordx4 v1, s[20:23], s48 offen offset:3072 sc1 lds
    s_add_u32 m0, s54, 12288
    s_add_u32 s48, s53, 12288
    buffer_load_dwordx4 v1, s[20:23], s48 offen offset:0 sc1 lds
    buffer_load_dwordx4 v1, s[20:23], s48 offen offset:1024 sc1 lds
    buffer_load_dwordx4 v1, s[20:23], s48 offen offset:2048 sc1 lds
    buffer_load_dwordx4 v1, s[20:23], s48 offen offset:3072 sc1 lds
    s_setprio 0
    s_waitcnt vmcnt(0)
    s_mov_b64 exec, 1
    ds_add_u32 v2, v3
    s_mov_b64 exec, -1
    v_and_b32 v4, 3, v0
    v_lshlrev_b32 v4, 2, v4
    v_add_u32 v4, 150544, v4
    s_movk_i32 s48, 300
L_adone:
    ds_read_b32 v145, v5 offset:0
    s_waitcnt lgkmcnt(0)
    v_cmp_gt_u32 vcc, s48, v145
    s_nop 0
    s_cbranch_vccz L_adone_ok
    s_sleep 2
    s_branch L_adone
L_adone_ok:
    v_mfma_f32_32x32x16_bf16 v[8:23], v[72:75], v[80:83], v[8:23]
    v_mfma_f32_32x32x16_bf16 v[24:39], v[72:75], v[84:87], v[24:39]
    v_mfma_f32_32x32x16_bf16 v[40:55], v[76:79], v[80:83], v[40:55]
    v_mfma_f32_32x32x16_bf16 v[56:71], v[76:79], v[84:87], v[56:71]
    v_mfma_f32_32x32x16_bf16 v[8:23], v[88:91], v[96:99], v[8:23]
    v_mfma_f32_32x32x16_bf16 v[24:39], v[88:91], v[100:103], v[24:39]
    v_mfma_f32_32x32x16_bf16 v[40:55], v[92:95], v[96:99], v[40:55]
    v_mfma_f32_32x32x16_bf16 v[56:71], v[92:95], v[100:103], v[56:71]
    v_mfma_f32_32x32x16_bf16 v[8:23], v[104:107], v[112:115], v[8:23]
    v_mfma_f32_32x32x16_bf16 v[24:39], v[104:107], v[116:119], v[24:39]
    v_mfma_f32_32x32x16_bf16 v[40:55], v[108:111], v[112:115], v[40:55]
    v_mfma_f32_32x32x16_bf16 v[56:71], v[108:111], v[116:119], v[56:71]
    v_mfma_f32_32x32x16_bf16 v[8:23], v[120:123], v[128:131], v[8:23]
    v_mfma_f32_32x32x16_bf16 v[24:39], v[120:123], v[132:135], v[24:39]
    v_mfma_f32_32x32x16_bf16 v[40:55], v[124:127], v[128:131], v[40:55]
    v_mfma_f32_32x32x16_bf16 v[56:71], v[124:127], v[132:135], v[56:71]
    s_nop 4
    s_setprio 2
    s_xor_b32 s59, s39, 1
    s_and_b32 s48, s59, 1
    s_mul_i32 s48, s48, 12288
    s_lshr_b32 s47, s59, 1
    s_mul_i32 s47, s47, 98304
    s_add_u32 s47, s47, s48
    v_add_u32 v4, s47, v1
    ds_write_b128 v4, v[24:27] offset:0
    ds_write_b128 v4, v[28:31] offset:1024
    ds_write_b128 v4, v[32:35] offset:2048
    ds_write_b128 v4, v[36:39] offset:3072
    s_xor_b32 s59, s39, 2
    s_and_b32 s48, s59, 1
    s_mul_i32 s48, s48, 12288
    s_lshr_b32 s47, s59, 1
    s_mul_i32 s47, s47, 98304
    s_add_u32 s47, s47, s48
    v_add_u32 v4, s47, v1
    ds_write_b128 v4, v[40:43] offset:4096
    ds_write_b128 v4, v[44:47] offset:5120
    ds_write_b128 v4, v[48:51] offset:6144
    ds_write_b128 v4, v[52:55] offset:7168
    s_xor_b32 s59, s39, 3
    s_and_b32 s48, s59, 1
    s_mul_i32 s48, s48, 12288
    s_lshr_b32 s47, s59, 1
    s_mul_i32 s47, s47, 98304
    s_add_u32 s47, s47, s48
    v_add_u32 v4, s47, v1
    ds_write_b128 v4, v[56:59] offset:8192
    ds_write_b128 v4, v[60:63] offset:9216
    ds_write_b128 v4, v[64:67] offset:10240
    ds_write_b128 v4, v[68:71] offset:11264
    s_mov_b64 exec, 1
    ds_add_u32 v2, v3
    s_mov_b64 exec, -1
    s_and_b32 s48, s39, 1
    s_mul_i32 s48, s48, 12288
    s_lshr_b32 s47, s39, 1
    s_mul_i32 s47, s47, 98304
    s_add_u32 s47, s47, s48
    v_add_u32 v4, s47, v1
L_fw1:
    ds_read_b32 v145, v2 offset:0
    s_waitcnt lgkmcnt(0)
    v_cmp_gt_u32 vcc, 8, v145
    s_nop 0
    s_cbranch_vccz L_fw1_ok
    s_sleep 1
    s_branch L_fw1
L_fw1_ok:
    ds_read_b128 v[24:27], v4 offset:0
    ds_read_b128 v[28:31], v4 offset:1024
    ds_read_b128 v[32:35], v4 offset:2048
    ds_read_b128 v[36:39], v4 offset:3072
    ds_read_b128 v[40:43], v4 offset:4096
    ds_read_b128 v[44:47], v4 offset:5120
    ds_read_b128 v[48:51], v4 offset:6144
    ds_read_b128 v[52:55], v4 offset:7168
    ds_read_b128 v[56:59], v4 offset:8192
    ds_read_b128 v[60:63], v4 offset:9216
    ds_read_b128 v[64:67], v4 offset:10240
    ds_read_b128 v[68:71], v4 offset:11264
    s_waitcnt lgkmcnt(8)
    v_add_f32 v8, v8, v24
    v_add_f32 v9, v9, v25
    v_add_f32 v10, v10, v26
    v_add_f32 v11, v11, v27
    v_add_f32 v12, v12, v28
    v_add_f32 v13, v13, v29
    v_add_f32 v14, v14, v30
    v_add_f32 v15, v15, v31
    v_add_f32 v16, v16, v32
    v_add_f32 v17, v17, v33
    v_add_f32 v18, v18, v34
    v_add_f32 v19, v19, v35
    v_add_f32 v20, v20, v36
    v_add_f32 v21, v21, v37
    v_add_f32 v22, v22, v38
    v_add_f32 v23, v23, v39
    s_waitcnt lgkmcnt(4)
    v_add_f32 v8, v8, v40
    v_add_f32 v9, v9, v41
    v_add_f32 v10, v10, v42
    v_add_f32 v11, v11, v43
    v_add_f32 v12, v12, v44
    v_add_f32 v13, v13, v45
    v_add_f32 v14, v14, v46
    v_add_f32 v15, v15, v47
    v_add_f32 v16, v16, v48
    v_add_f32 v17, v17, v49
    v_add_f32 v18, v18, v50
    v_add_f32 v19, v19, v51
    v_add_f32 v20, v20, v52
    v_add_f32 v21, v21, v53
    v_add_f32 v22, v22, v54
    v_add_f32 v23, v23, v55
    s_waitcnt lgkmcnt(0)
    s_mov_b64 exec, 1
    ds_add_u32 v2, v3
    s_mov_b64 exec, -1
    v_add_f32 v8, v8, v56
    v_add_f32 v9, v9, v57
    v_add_f32 v10, v10, v58
    v_add_f32 v11, v11, v59
    v_add_f32 v12, v12, v60
    v_add_f32 v13, v13, v61
    v_add_f32 v14, v14, v62
    v_add_f32 v15, v15, v63
    v_add_f32 v16, v16, v64
    v_add_f32 v17, v17, v65
    v_add_f32 v18, v18, v66
    v_add_f32 v19, v19, v67
    v_add_f32 v20, v20, v68
    v_add_f32 v21, v21, v69
    v_add_f32 v22, v22, v70
    v_add_f32 v23, v23, v71
    v_lshlrev_b32 v24, 16, v136
    v_and_b32 v25, 0xffff0000, v136
    v_lshlrev_b32 v26, 16, v137
    v_and_b32 v27, 0xffff0000, v137
    v_lshlrev_b32 v28, 16, v138
    v_and_b32 v29, 0xffff0000, v138
    v_lshlrev_b32 v30, 16, v139
    v_and_b32 v31, 0xffff0000, v139
    v_lshlrev_b32 v32, 16, v140
    v_and_b32 v33, 0xffff0000, v140
    v_lshlrev_b32 v34, 16, v141
    v_and_b32 v35, 0xffff0000, v141
    v_lshlrev_b32 v36, 16, v142
    v_and_b32 v37, 0xffff0000, v142
    v_lshlrev_b32 v38, 16, v143
    v_and_b32 v39, 0xffff0000, v143
    v_mov_b32 v92, v144
    s_mov_b32 s47, s49
L_wordy:
    ds_read_b32 v93, v2 offset:0
    s_waitcnt lgkmcnt(0)
    v_cmp_gt_u32 vcc, 12, v93
    s_nop 0
    s_cbranch_vccz L_wordy_ok
    s_sleep 1
    s_branch L_wordy
L_wordy_ok:
    ds_read_b128 v[96:99], v163 offset:0
    ds_read_b128 v[100:103], v163 offset:1024
    ds_read_b128 v[104:107], v163 offset:2048
    ds_read_b128 v[108:111], v163 offset:3072
    ds_read_b128 v[112:115], v163 offset:4096
    ds_read_b128 v[116:119], v163 offset:5120
    ds_read_b128 v[120:123], v163 offset:6144
    ds_read_b128 v[124:127], v163 offset:7168
    ds_read_b128 v[128:131], v163 offset:8192
    ds_read_b128 v[132:135], v163 offset:9216
    ds_read_b128 v[136:139], v163 offset:10240
    ds_read_b128 v[140:143], v163 offset:11264
    ds_read_b128 v[144:147], v163 offset:12288
    ds_read_b128 v[148:151], v163 offset:13312
    ds_read_b128 v[152:155], v163 offset:14336
    ds_read_b128 v[156:159], v163 offset:15360
    s_barrier
    s_setprio 3
    s_mov_b32 s58, 200000
    s_mov_b64 exec, 0xffff
    buffer_load_dwordx2 v[88:89], v7, s[20:23], s50 offen sc1
    s_mov_b64 exec, -1
    v_mul_f32 v8, v8, v92
    v_mul_f32 v9, v9, v92
    v_mul_f32 v10, v10, v92
    v_mul_f32 v11, v11, v92
    v_mul_f32 v12, v12, v92
    v_mul_f32 v13, v13, v92
    v_mul_f32 v14, v14, v92
    v_mul_f32 v15, v15, v92
    v_mul_f32 v16, v16, v92
    v_mul_f32 v17, v17, v92
    v_mul_f32 v18, v18, v92
    v_mul_f32 v19, v19, v92
    v_mul_f32 v20, v20, v92
    v_mul_f32 v21, v21, v92
    v_mul_f32 v22, v22, v92
    v_mul_f32 v23, v23, v92
    v_mul_f32 v64, 0xbfb8aa3b, v8
    v_mul_f32 v65, 0xbfb8aa3b, v9
    v_mul_f32 v66, 0xbfb8aa3b, v10
    v_mul_f32 v67, 0xbfb8aa3b, v11
    v_mul_f32 v68, 0xbfb8aa3b, v12
    v_mul_f32 v69, 0xbfb8aa3b, v13
    v_mul_f32 v70, 0xbfb8aa3b, v14
    v_mul_f32 v71, 0xbfb8aa3b, v15
    v_mul_f32 v72, 0xbfb8aa3b, v16
    v_mul_f32 v73, 0xbfb8aa3b, v17
    v_mul_f32 v74, 0xbfb8aa3b, v18
    v_mul_f32 v75, 0xbfb8aa3b, v19
    v_mul_f32 v76, 0xbfb8aa3b, v20
    v_mul_f32 v77, 0xbfb8aa3b, v21
    v_mul_f32 v78, 0xbfb8aa3b, v22
    v_mul_f32 v79, 0xbfb8aa3b, v23
    v_exp_f32 v64, v64
    v_exp_f32 v65, v65
    v_exp_f32 v66, v66
    v_exp_f32 v67, v67
    v_exp_f32 v68, v68
    v_exp_f32 v69, v69
    v_exp_f32 v70, v70
    v_exp_f32 v71, v71
    v_exp_f32 v72, v72
    v_exp_f32 v73, v73
    v_exp_f32 v74, v74
    v_exp_f32 v75, v75
    v_exp_f32 v76, v76
    v_exp_f32 v77, v77
    v_exp_f32 v78, v78
    v_exp_f32 v79, v79
    v_add_f32 v64, 1.0, v64
    v_add_f32 v65, 1.0, v65
    v_add_f32 v66, 1.0, v66
    v_add_f32 v67, 1.0, v67
    v_add_f32 v68, 1.0, v68
    v_add_f32 v69, 1.0, v69
    v_add_f32 v70, 1.0, v70
    v_add_f32 v71, 1.0, v71
    v_add_f32 v72, 1.0, v72
    v_add_f32 v73, 1.0, v73
    v_add_f32 v74, 1.0, v74
    v_add_f32 v75, 1.0, v75
    v_add_f32 v76, 1.0, v76
    v_add_f32 v77, 1.0, v77
    v_add_f32 v78, 1.0, v78
    v_add_f32 v79, 1.0, v79
    v_rcp_f32 v64, v64
    v_rcp_f32 v65, v65
    v_rcp_f32 v66, v66
    v_rcp_f32 v67, v67
    v_rcp_f32 v68, v68
    v_rcp_f32 v69, v69
    v_rcp_f32 v70, v70
    v_rcp_f32 v71, v71
    v_rcp_f32 v72, v72
    v_rcp_f32 v73, v73
    v_rcp_f32 v74, v74
    v_rcp_f32 v75, v75
    v_rcp_f32 v76, v76
    v_rcp_f32 v77, v77
    v_rcp_f32 v78, v78
    v_rcp_f32 v79, v79
    v_mul_f32 v8, v8, v64
    v_mul_f32 v9, v9, v65
    v_mul_f32 v10, v10, v66
    v_mul_f32 v11, v11, v67
    v_mul_f32 v12, v12, v68
    v_mul_f32 v13, v13, v69
    v_mul_f32 v14, v14, v70
    v_mul_f32 v15, v15, v71
    v_mul_f32 v16, v16, v72
    v_mul_f32 v17, v17, v73
    v_mul_f32 v18, v18, v74
    v_mul_f32 v19, v19, v75
    v_mul_f32 v20, v20, v76
    v_mul_f32 v21, v21, v77
    v_mul_f32 v22, v22, v78
    v_mul_f32 v23, v23, v79
    s_mov_b64 exec, 0xffff
    s_branch L_pf3_chk
L_pf3:
    buffer_load_dwordx2 v[88:89], v7, s[20:23], s50 offen sc1
L_pf3_chk:
    s_waitcnt vmcnt(0)
    v_xor_b32 v88, s18, v88
    v_xor_b32 v89, s19, v89
    v_or_b32 v88, v88, v89
    v_cmp_ne_u32 vcc, 0, v88
    s_sub_u32 s58, s58, 1
    s_cbranch_scc1 L_pf3_ok
    s_cbranch_vccz L_pf3_ok
    s_sleep 1
    s_branch L_pf3
L_pf3_ok:
    s_mov_b64 exec, -1
    s_add_u32 m0, s47, 0
    s_add_u32 s48, s55, 0
    buffer_load_dwordx4 v1, s[20:23], s48 offen sc1 lds
    s_add_u32 m0, s47, 98304
    s_add_u32 s48, s55, 32768
    buffer_load_dwordx4 v1, s[20:23], s48 offen sc1 lds
    s_add_u32 m0, s47, 4096
    s_add_u32 s48, s55, 4096
    buffer_load_dwordx4 v1, s[20:23], s48 offen sc1 lds
    s_add_u32 m0, s47, 102400
    s_add_u32 s48, s55, 36864
    buffer_load_dwordx4 v1, s[20:23], s48 offen sc1 lds
    s_add_u32 m0, s47, 8192
    s_add_u32 s48, s55, 8192
    buffer_load_dwordx4 v1, s[20:23], s48 offen sc1 lds
    s_add_u32 m0, s47, 106496
    s_add_u32 s48, s55, 40960
    buffer_load_dwordx4 v1, s[20:23], s48 offen sc1 lds
    s_add_u32 m0, s47, 12288
    s_add_u32 s48, s55, 12288
    buffer_load_dwordx4 v1, s[20:23], s48 offen sc1 lds
    s_add_u32 m0, s47, 110592
    s_add_u32 s48, s55, 45056
    buffer_load_dwordx4 v1, s[20:23], s48 offen sc1 lds
    s_add_u32 m0, s47, 16384
    s_add_u32 s48, s55, 16384
    buffer_load_dwordx4 v1, s[20:23], s48 offen sc1 lds
    s_add_u32 m0, s47, 114688
    s_add_u32 s48, s55, 49152
    buffer_load_dwordx4 v1, s[20:23], s48 offen sc1 lds
    s_add_u32 m0, s47, 20480
    s_add_u32 s48, s55, 20480
    buffer_load_dwordx4 v1, s[20:23], s48 offen sc1 lds
    s_add_u32 m0, s47, 118784
    s_add_u32 s48, s55, 53248
    buffer_load_dwordx4 v1, s[20:23], s48 offen sc1 lds
    s_add_u32 m0, s47, 24576
    s_add_u32 s48, s55, 24576
    buffer_load_dwordx4 v1, s[20:23], s48 offen sc1 lds
    s_add_u32 m0, s47, 122880
    s_add_u32 s48, s55, 57344
    buffer_load_dwordx4 v1, s[20:23], s48 offen sc1 lds
    s_add_u32 m0, s47, 28672
    s_add_u32 s48, s55, 28672
    buffer_load_dwordx4 v1, s[20:23], s48 offen sc1 lds
    s_add_u32 m0, s47, 126976
    s_add_u32 s48, s55, 61440
    buffer_load_dwordx4 v1, s[20:23], s48 offen sc1 lds
    s_waitcnt vmcnt(12) lgkmcnt(0)
    s_barrier
    ds_read_b128 v[64:67], v162 offset:0
    ds_read_b128 v[68:71], v162 offset:1024
    ds_read_b128 v[72:75], v162 offset:2048
    ds_read_b128 v[76:79], v162 offset:3072
    ds_read_b128 v[80:83], v162 offset:4096
    ds_read_b128 v[84:87], v162 offset:5120
    s_waitcnt lgkmcnt(5)
    v_mfma_f32_32x32x16_bf16 v[48:63], v[96:99], v[64:67], 0
    ds_read_b128 v[64:67], v162 offset:6144
    ds_read_b128 v[96:99], v163 offset:16384
    s_waitcnt lgkmcnt(6)
    v_mfma_f32_32x32x16_bf16 v[48:63], v[100:103], v[68:71], v[48:63]
    ds_read_b128 v[68:71], v162 offset:7168
    ds_read_b128 v[100:103], v163 offset:17408
    s_waitcnt lgkmcnt(7)
    v_mfma_f32_32x32x16_bf16 v[48:63], v[104:107], v[72:75], v[48:63]
    ds_read_b128 v[104:107], v163 offset:18432
    s_waitcnt lgkmcnt(7)
    v_mfma_f32_32x32x16_bf16 v[48:63], v[108:111], v[76:79], v[48:63]
    ds_read_b128 v[108:111], v163 offset:19456
    s_waitcnt lgkmcnt(7)
    v_mfma_f32_32x32x16_bf16 v[48:63], v[112:115], v[80:83], v[48:63]
    s_waitcnt vmcnt(8)
    s_barrier
    ds_read_b128 v[72:75], v162 offset:8192
    ds_read_b128 v[76:79], v162 offset:9216
    ds_read_b128 v[80:83], v162 offset:10240
    ds_read_b128 v[112:115], v163 offset:20480
    s_waitcnt lgkmcnt(10)
    v_mfma_f32_32x32x16_bf16 v[48:63], v[116:119], v[84:87], v[48:63]
    ds_read_b128 v[84:87], v162 offset:11264
    ds_read_b128 v[116:119], v163 offset:21504
    s_waitcnt lgkmcnt(11)
    v_mfma_f32_32x32x16_bf16 v[48:63], v[120:123], v[64:67], v[48:63]
    ds_read_b128 v[64:67], v162 offset:12288
    ds_read_b128 v[120:123], v163 offset:22528
    s_waitcnt lgkmcnt(11)
    v_mfma_f32_32x32x16_bf16 v[48:63], v[124:127], v[68:71], v[48:63]
    ds_read_b128 v[68:71], v162 offset:13312
    ds_read_b128 v[124:127], v163 offset:23552
    s_waitcnt lgkmcnt(9)
    v_mfma_f32_32x32x16_bf16 v[48:63], v[128:131], v[72:75], v[48:63]
    ds_read_b128 v[72:75], v162 offset:14336
    ds_read_b128 v[128:131], v163 offset:24576
    s_waitcnt lgkmcnt(10)
    v_mfma_f32_32x32x16_bf16 v[48:63], v[132:135], v[76:79], v[48:63]
    ds_read_b128 v[76:79], v162 offset:15360
    ds_read_b128 v[132:135], v163 offset:25600
    s_waitcnt lgkmcnt(11)
    v_mfma_f32_32x32x16_bf16 v[48:63], v[136:139], v[80:83], v[48:63]
    ds_read_b128 v[136:139], v163 offset:26624
    s_waitcnt lgkmcnt(10)
    v_mfma_f32_32x32x16_bf16 v[48:63], v[140:143], v[84:87], v[48:63]
    ds_read_b128 v[140:143], v163 offset:27648
    s_waitcnt lgkmcnt(9)
    v_mfma_f32_32x32x16_bf16 v[48:63], v[144:147], v[64:67], v[48:63]
    s_waitcnt vmcnt(4)
    s_barrier
    ds_read_b128 v[80:83], v162 offset:16384
    ds_read_b128 v[84:87], v162 offset:17408
    ds_read_b128 v[64:67], v162 offset:18432
    ds_read_b128 v[144:147], v163 offset:28672
    s_waitcnt lgkmcnt(11)
    v_mfma_f32_32x32x16_bf16 v[48:63], v[148:151], v[68:71], v[48:63]
    ds_read_b128 v[68:71], v162 offset:19456
    ds_read_b128 v[148:151], v163 offset:29696
    s_waitcnt lgkmcnt(11)
    v_mfma_f32_32x32x16_bf16 v[48:63], v[152:155], v[72:75], v[48:63]
    ds_read_b128 v[72:75], v162 offset:20480
    ds_read_b128 v[152:155], v163 offset:30720
    s_waitcnt lgkmcnt(11)
    v_mfma_f32_32x32x16_bf16 v[48:63], v[156:159], v[76:79], v[48:63]
    ds_read_b128 v[76:79], v162 offset:21504
    ds_read_b128 v[156:159], v163 offset:31744
    s_waitcnt lgkmcnt(9)
    v_mfma_f32_32x32x16_bf16 v[48:63], v[96:99], v[80:83], v[48:63]
    ds_read_b128 v[80:83], v162 offset:22528
    s_waitcnt lgkmcnt(9)
    v_mfma_f32_32x32x16_bf16 v[48:63], v[100:103], v[84:87], v[48:63]
    ds_read_b128 v[84:87], v162 offset:23552
    s_waitcnt lgkmcnt(9)
    v_mfma_f32_32x32x16_bf16 v[48:63], v[104:107], v[64:67], v[48:63]
    s_waitcnt lgkmcnt(7)
    v_mfma_f32_32x32x16_bf16 v[48:63], v[108:111], v[68:71], v[48:63]
    s_waitcnt lgkmcnt(5)
    v_mfma_f32_32x32x16_bf16 v[48:63], v[112:115], v[72:75], v[48:63]
    s_waitcnt vmcnt(0)
    s_barrier
    ds_read_b128 v[64:67], v162 offset:24576
    ds_read_b128 v[68:71], v162 offset:25600
    ds_read_b128 v[72:75], v162 offset:26624
    s_waitcnt lgkmcnt(6)
    v_mfma_f32_32x32x16_bf16 v[48:63], v[116:119], v[76:79], v[48:63]
    ds_read_b128 v[76:79], v162 offset:27648
    s_waitcnt lgkmcnt(5)
    v_mfma_f32_32x32x16_bf16 v[48:63], v[120:123], v[80:83], v[48:63]
    ds_read_b128 v[80:83], v162 offset:28672
    s_waitcnt lgkmcnt(5)
    v_mfma_f32_32x32x16_bf16 v[48:63], v[124:127], v[84:87], v[48:63]
    ds_read_b128 v[84:87], v162 offset:29696
    s_waitcnt lgkmcnt(5)
    v_mfma_f32_32x32x16_bf16 v[48:63], v[128:131], v[64:67], v[48:63]
    ds_read_b128 v[64:67], v162 offset:30720
    s_waitcnt lgkmcnt(5)
    v_mfma_f32_32x32x16_bf16 v[48:63], v[132:135], v[68:71], v[48:63]
    ds_read_b128 v[68:71], v162 offset:31744
    s_waitcnt lgkmcnt(5)
    v_mfma_f32_32x32x16_bf16 v[48:63], v[136:139], v[72:75], v[48:63]
    s_waitcnt lgkmcnt(4)
    v_mfma_f32_32x32x16_bf16 v[48:63], v[140:143], v[76:79], v[48:63]
    s_waitcnt lgkmcnt(3)
    v_mfma_f32_32x32x16_bf16 v[48:63], v[144:147], v[80:83], v[48:63]
    s_waitcnt lgkmcnt(2)
    v_mfma_f32_32x32x16_bf16 v[48:63], v[148:151], v[84:87], v[48:63]
    s_waitcnt lgkmcnt(1)
    v_mfma_f32_32x32x16_bf16 v[48:63], v[152:155], v[64:67], v[48:63]
    s_waitcnt lgkmcnt(0)
    v_mfma_f32_32x32x16_bf16 v[48:63], v[156:159], v[68:71], v[48:63]
    s_nop 11
    v_pk_mul_f32 v[48:49], v[48:49], v[8:9]
    v_pk_mul_f32 v[50:51], v[50:51], v[10:11]
    v_pk_mul_f32 v[52:53], v[52:53], v[12:13]
    v_pk_mul_f32 v[54:55], v[54:55], v[14:15]
    v_pk_mul_f32 v[56:57], v[56:57], v[16:17]
    v_pk_mul_f32 v[58:59], v[58:59], v[18:19]
    v_pk_mul_f32 v[60:61], v[60:61], v[20:21]
    v_pk_mul_f32 v[62:63], v[62:63], v[22:23]
    v_cvt_pk_bf16_f32 v40, v48, v49
    v_cvt_pk_bf16_f32 v41, v50, v51
    ds_write_b64 v160, v[40:41] offset:0
    v_cvt_pk_bf16_f32 v42, v52, v53
    v_cvt_pk_bf16_f32 v43, v54, v55
    ds_write_b64 v160, v[42:43] offset:16
    v_cvt_pk_bf16_f32 v44, v56, v57
    v_cvt_pk_bf16_f32 v45, v58, v59
    ds_write_b64 v160, v[44:45] offset:32
    v_cvt_pk_bf16_f32 v46, v60, v61
    v_cvt_pk_bf16_f32 v47, v62, v63
    ds_write_b64 v160, v[46:47] offset:48
    ds_read_b128 v[72:75], v161
    ds_read_b128 v[76:79], v161 offset:1280
    s_waitcnt lgkmcnt(1)
    v_lshlrev_b32 v8, 16, v72
    v_and_b32 v9, 0xffff0000, v72
    v_lshlrev_b32 v10, 16, v73
    v_and_b32 v11, 0xffff0000, v73
    v_lshlrev_b32 v12, 16, v74
    v_and_b32 v13, 0xffff0000, v74
    v_lshlrev_b32 v14, 16, v75
    v_and_b32 v15, 0xffff0000, v75
    v_pk_add_f32 v[8:9], v[8:9], v[24:25]
    v_pk_add_f32 v[10:11], v[10:11], v[26:27]
    v_pk_add_f32 v[12:13], v[12:13], v[28:29]
    v_pk_add_f32 v[14:15], v[14:15], v[30:31]
    v_cvt_pk_bf16_f32 v48, v8, v9
    v_cvt_pk_bf16_f32 v49, v10, v11
    v_cvt_pk_bf16_f32 v50, v12, v13
    v_cvt_pk_bf16_f32 v51, v14, v15
    buffer_store_dwordx4 v[48:51], v6, s[24:27], s51 offen
    s_waitcnt lgkmcnt(0)
    v_lshlrev_b32 v16, 16, v76
    v_and_b32 v17, 0xffff0000, v76
    v_lshlrev_b32 v18, 16, v77
    v_and_b32 v19, 0xffff0000, v77
    v_lshlrev_b32 v20, 16, v78
    v_and_b32 v21, 0xffff0000, v78
    v_lshlrev_b32 v22, 16, v79
    v_and_b32 v23, 0xffff0000, v79
    v_pk_add_f32 v[16:17], v[16:17], v[32:33]
    v_pk_add_f32 v[18:19], v[18:19], v[34:35]
    v_pk_add_f32 v[20:21], v[20:21], v[36:37]
    v_pk_add_f32 v[22:23], v[22:23], v[38:39]
    v_cvt_pk_bf16_f32 v52, v16, v17
    v_cvt_pk_bf16_f32 v53, v18, v19
    v_cvt_pk_bf16_f32 v54, v20, v21
    v_cvt_pk_bf16_f32 v55, v22, v23
    buffer_store_dwordx4 v[52:55], v6, s[24:27], s52 offen
    s_or_b32 s48, s2, s39
    s_cbranch_scc1 L_now0
    v_mov_b32 v64, s18
    v_mov_b32 v65, s19
    v_mov_b32 v66, 0
    s_mov_b64 exec, 1
    buffer_store_dwordx2 v[64:65], v66, s[20:23], 0 offen sc1
    s_mov_b64 exec, -1
L_now0:
    s_endpgm
L_cons:
    s_setprio 1
    v_and_b32 v2, 31, v0
    v_mov_b32 v8, 0
    v_lshl_add_u32 v5, v2, 2, 0
    v_add_u32 v5, 150528, v5
    ds_write_b32 v5, v8
    v_mov_b32 v25, 0
    v_mov_b32 v28, 0
    v_mov_b32 v29, 0
    v_mov_b32 v30, 0
    v_mov_b32 v31, 0
    v_mov_b32 v32, 0
    v_mov_b32 v33, 0
    v_mov_b32 v34, 0
    v_mov_b32 v35, 0
    v_lshrrev_b32 v3, 5, v0
    v_bfe_u32 v4, v0, 1, 3
    v_mfma_f32_32x32x16_bf16 v[100:115], v[28:31], v[28:31], 0
    v_mfma_f32_32x32x16_bf16 v[116:131], v[28:31], v[28:31], 0
    v_mfma_f32_32x32x16_bf16 v[132:147], v[28:31], v[28:31], 0
    v_mfma_f32_32x32x16_bf16 v[148:163], v[28:31], v[28:31], 0
    v_xor_b32 v4, v4, v3
    v_lshlrev_b32 v4, 4, v4
    v_lshl_add_u32 v4, v2, 7, v4
    v_and_b32 v167, 3, v0
    v_lshlrev_b32 v167, 2, v167
    v_add_u32 v167, 150528, v167
    s_lshl_b32 s48, s38, 2
    s_add_u32 s48, s48, 150528
    v_cmp_eq_u32 vcc, 0, v0
    v_mov_b32 v27, 0x7ffffff0
    v_mov_b32 v5, s48
    s_lshr_b32 s43, s38, 3
    v_cndmask_b32 v27, v27, v5, vcc
    v_lshrrev_b32 v6, 5, v0
    v_bfe_u32 v7, v0, 2, 2
    v_lshl_add_u32 v6, v6, 3, v7
    v_lshlrev_b32 v6, 6, v6
    v_bfe_u32 v7, v0, 4, 1
    v_lshl_add_u32 v6, v7, 5, v6
    v_and_b32 v7, 3, v0
    v_lshl_add_u32 v11, v7, 3, v6
    v_lshrrev_b32 v6, 2, v0
    v_xor_b32 v6, v6, v0
    v_and_b32 v6, 8, v6
    v_and_or_b32 v6, v0, 6, v6
    v_mov_b32 v7, 0x3f803f80
    v_cmp_eq_u32 vcc, 0, v6
    v_cmp_eq_u32 s[50:51], 4, v6
    v_and_b32 v9, 1, v0
    v_cndmask_b32 v20, v8, v7, vcc
    v_cndmask_b32 v21, v8, v7, vcc
    v_cndmask_b32 v22, v8, v7, s[50:51]
    v_cndmask_b32 v23, v8, v7, s[50:51]
    v_mul_u32_u24 v9, 0xaaaa, v9
    v_add_u32 v24, 0x4444, v9
    s_lshl_b32 s52, s39, 12
    s_mov_b32 s53, 98304
    v_add_u32 v5, s52, v4
    s_add_u32 s48, s39, 0
    s_and_b32 s48, s48, 3
    s_lshl_b32 s50, s48, 5
    v_xor_b32 v12, s50, v5
    s_mul_i32 s48, s48, 3072
    s_add_u32 s48, s48, s53
    v_add_u32 v16, s48, v11
    s_add_u32 s48, s39, 1
    s_and_b32 s48, s48, 3
    s_lshl_b32 s50, s48, 5
    v_xor_b32 v13, s50, v5
    s_mul_i32 s48, s48, 3072
    s_add_u32 s48, s48, s53
    v_add_u32 v17, s48, v11
    s_add_u32 s48, s39, 2
    s_and_b32 s48, s48, 3
    s_lshl_b32 s50, s48, 5
    v_xor_b32 v14, s50, v5
    s_mul_i32 s48, s48, 3072
    s_add_u32 s48, s48, s53
    v_add_u32 v18, s48, v11
    s_add_u32 s48, s39, 3
    s_and_b32 s48, s48, 3
    s_lshl_b32 s50, s48, 5
    v_xor_b32 v15, s50, v5
    s_mul_i32 s48, s48, 3072
    s_add_u32 s48, s48, s53
    v_add_u32 v19, s48, v11
    s_and_b32 s3, s2, 7
    s_lshl_b32 s3, s3, 2
    s_bfe_u32 s40, s2, 0x20003
    s_add_u32 s40, s40, s3
    s_lshr_b32 s41, s2, 5
    s_mov_b32 s22, 0x1300000
    s_mov_b32 s23, 0x20000
    s_mov_b32 s52, 16384
    s_movk_i32 s42, 12288
    s_mov_b32 s53, -16384
    s_mov_b32 s44, 0
    s_lshl_b32 s47, s36, 2
    s_add_u32 s47, s47, s39
    s_cmp_lg_u32 s43, 0
    s_waitcnt lgkmcnt(0)
    s_load_dwordx2 s[18:19], s[20:21], 0
    s_cbranch_scc1 L_stats0
    s_lshl_b32 s48, s39, 2
    s_add_u32 s48, s48, 147456
    s_lshl_b32 s49, s39, 8
    s_add_u32 s49, s49, 149504
    v_and_b32 v5, 7, v0
    v_lshlrev_b32 v5, 2, v5
    v_lshlrev_b32 v6, 4, v2
    v_bfe_u32 v7, v0, 4, 1
    v_lshlrev_b32 v7, 16, v7
    v_lshl_add_u32 v7, v3, 9, v7
    v_and_b32 v9, 15, v0
    v_lshrrev_b32 v10, 1, v0
    v_xor_b32 v10, v10, v0
    v_and_b32 v10, 4, v10
    v_mul_u32_u24 v10, 3, v10
    v_xor_b32 v10, v10, v0
    v_add_u32 v155, s48, v1
    v_add_u32 v156, 150544, v5
    v_lshl_add_u32 v157, v2, 3, s49
    v_lshl_add_u32 v158, v3, 5, s49
    v_add_u32 v159, 147456, v6
    v_lshl_add_u32 v154, v9, 4, v7
    v_lshlrev_b32 v153, 4, v10
    s_mul_i32 s57, s37, 3
    s_lshl_b32 s56, s57, 7
    s_add_u32 s56, s56, s47
    s_lshl_b32 s56, s56, 10
    s_add_u32 s56, s56, 1048576
    s_cmp_ge_u32 s57, 16
    s_cselect_b64 vcc, -1, 0
    s_nop 1
    v_cndmask_b32 v160, v1, v153, vcc
    s_cmp_ge_u32 s57, 15
    s_cselect_b64 vcc, -1, 0
    s_nop 1
    v_cndmask_b32 v161, v1, v153, vcc
    s_cmp_ge_u32 s57, 14
    s_cselect_b64 vcc, -1, 0
    s_nop 1
    v_cndmask_b32 v162, v1, v153, vcc
    s_waitcnt lgkmcnt(0)
    s_barrier
    ds_read_b128 v[48:51], v12
    ds_read_b64_tr_b16 v[36:37], v16 offset:0
    ds_read_b64_tr_b16 v[38:39], v16 offset:256
    ds_read_b64_tr_b16 v[40:41], v16 offset:1024
    ds_read_b64_tr_b16 v[42:43], v16 offset:1280
    ds_read_b64_tr_b16 v[44:45], v16 offset:2048
    ds_read_b64_tr_b16 v[46:47], v16 offset:2304
    ds_read_b128 v[64:67], v13
    ds_read_b64_tr_b16 v[52:53], v17 offset:0
    ds_read_b64_tr_b16 v[54:55], v17 offset:256
    ds_read_b64_tr_b16 v[56:57], v17 offset:1024
    ds_read_b64_tr_b16 v[58:59], v17 offset:1280
    ds_read_b64_tr_b16 v[60:61], v17 offset:2048
    ds_read_b64_tr_b16 v[62:63], v17 offset:2304
    ds_read_b128 v[80:83], v14
    ds_read_b64_tr_b16 v[68:69], v18 offset:0
    ds_read_b64_tr_b16 v[70:71], v18 offset:256
    ds_read_b64_tr_b16 v[72:73], v18 offset:1024
    ds_read_b64_tr_b16 v[74:75], v18 offset:1280
    ds_read_b64_tr_b16 v[76:77], v18 offset:2048
    ds_read_b64_tr_b16 v[78:79], v18 offset:2304
    s_cmp_eq_u32 s37, 10
    s_cbranch_scc1 L_qkv1
    s_cmp_gt_u32 s37, 10
    s_cbranch_scc1 L_qkv2
L_qkv0:
    s_waitcnt lgkmcnt(14)
    v_mfma_f32_32x32x16_bf16 v[100:115], v[36:39], v[48:51], v[100:115]
    ds_read_b128 v[96:99], v15
    ds_read_b64_tr_b16 v[84:85], v19 offset:0
    ds_read_b64_tr_b16 v[86:87], v19 offset:256
    v_mfma_f32_32x32x16_bf16 v[116:131], v[40:43], v[48:51], v[116:131]
    ds_read_b64_tr_b16 v[88:89], v19 offset:1024
    ds_read_b64_tr_b16 v[90:91], v19 offset:1280
    ds_read_b64_tr_b16 v[92:93], v19 offset:2048
    ds_read_b64_tr_b16 v[94:95], v19 offset:2304
    v_mfma_f32_32x32x16_bf16 v[132:147], v[44:47], v[48:51], v[132:147]
    v_smfmac_f32_16x16x64_bf16 v[28:31], v[20:23], v[36:43], v24
    v_smfmac_f32_16x16x64_bf16 v[32:35], v[20:23], v[44:51], v24
    s_cmp_eq_u32 s44, 7
    s_waitcnt lgkmcnt(14)
    v_mfma_f32_32x32x16_bf16 v[100:115], v[52:55], v[64:67], v[100:115]
    s_cbranch_scc1 L_qkv_x0
    s_cmp_eq_u32 s44, 4
    s_cselect_b32 s45, -65536, s52
    s_and_b32 s48, s44, 3
    s_cmp_eq_u32 s48, 3
    s_cselect_b32 s46, -36864, s42
    s_add_u32 s44, s44, 1
    v_add_u32 v12, s45, v12
    v_add_u32 v16, s46, v16
    v_add_u32 v13, s45, v13
    v_add_u32 v17, s46, v17
    v_mfma_f32_32x32x16_bf16 v[116:131], v[56:59], v[64:67], v[116:131]
    v_add_u32 v14, s45, v14
    v_add_u32 v18, s46, v18
    v_add_u32 v15, s45, v15
    v_add_u32 v19, s46, v19
    s_waitcnt lgkmcnt(0)
    v_mfma_f32_32x32x16_bf16 v[132:147], v[60:63], v[64:67], v[132:147]
    s_barrier
    v_mfma_f32_32x32x16_bf16 v[100:115], v[68:71], v[80:83], v[100:115]
    ds_read_b128 v[48:51], v12
    ds_read_b64_tr_b16 v[36:37], v16 offset:0
    ds_read_b64_tr_b16 v[38:39], v16 offset:256
    v_mfma_f32_32x32x16_bf16 v[116:131], v[72:75], v[80:83], v[116:131]
    ds_read_b64_tr_b16 v[40:41], v16 offset:1024
    ds_read_b64_tr_b16 v[42:43], v16 offset:1280
    ds_read_b64_tr_b16 v[44:45], v16 offset:2048
    ds_read_b64_tr_b16 v[46:47], v16 offset:2304
    v_mfma_f32_32x32x16_bf16 v[132:147], v[76:79], v[80:83], v[132:147]
    ds_read_b128 v[64:67], v13
    ds_read_b64_tr_b16 v[52:53], v17 offset:0
    ds_read_b64_tr_b16 v[54:55], v17 offset:256
    v_mfma_f32_32x32x16_bf16 v[100:115], v[84:87], v[96:99], v[100:115]
    ds_read_b64_tr_b16 v[56:57], v17 offset:1024
    ds_read_b64_tr_b16 v[58:59], v17 offset:1280
    ds_read_b64_tr_b16 v[60:61], v17 offset:2048
    ds_read_b64_tr_b16 v[62:63], v17 offset:2304
    v_mfma_f32_32x32x16_bf16 v[116:131], v[88:91], v[96:99], v[116:131]
    ds_read_b128 v[80:83], v14
    ds_read_b64_tr_b16 v[68:69], v18 offset:0
    ds_read_b64_tr_b16 v[70:71], v18 offset:256
    v_mfma_f32_32x32x16_bf16 v[132:147], v[92:95], v[96:99], v[132:147]
    ds_read_b64_tr_b16 v[72:73], v18 offset:1024
    ds_read_b64_tr_b16 v[74:75], v18 offset:1280
    ds_read_b64_tr_b16 v[76:77], v18 offset:2048
    ds_read_b64_tr_b16 v[78:79], v18 offset:2304
    s_branch L_qkv0
L_qkv_x0:
    v_mfma_f32_32x32x16_bf16 v[116:131], v[56:59], v[64:67], v[116:131]
    s_setprio 3
    v_mov_b32 v9, 100
    v_cmp_eq_u32 s[58:59], 0, v3
    s_nop 1
    v_add_f32 v4, v28, v29
    v_add_f32 v7, v32, v33
    v_mfma_f32_32x32x16_bf16 v[132:147], v[60:63], v[64:67], v[132:147]
    v_cvt_pk_bf16_f32 v6, v4, v4
    v_cvt_pk_bf16_f32 v10, v7, v7
    v_and_b32 v6, 0xffff0000, v6
    v_and_b32 v10, 0xffff0000, v10
    v_sub_f32 v6, v4, v6
    v_sub_f32 v10, v7, v10
    v_cvt_pk_bf16_f32 v6, v4, v6
    v_cvt_pk_bf16_f32 v10, v7, v10
    s_waitcnt lgkmcnt(0)
    ds_write_b32 v155, v6
    ds_write_b32 v155, v10 offset:1024
    ds_write_b32 v27, v9
    v_mfma_f32_32x32x16_bf16 v[100:115], v[68:71], v[80:83], v[100:115]
    v_mfma_f32_32x32x16_bf16 v[116:131], v[72:75], v[80:83], v[116:131]
L_e10:
    ds_read_b32 v8, v156 offset:0
    s_waitcnt lgkmcnt(0)
    v_cmp_gt_u32 vcc, 8, v8
    s_nop 0
    s_cbranch_vccz L_e10_ok
    s_sleep 1
    s_branch L_e10
L_e10_ok:
    ds_read_b64 v[8:9], v157
    ds_read_b128 v[36:39], v159 offset:0
    ds_read_b128 v[40:43], v159 offset:512
    ds_read_b128 v[44:47], v159 offset:1024
    v_mfma_f32_32x32x16_bf16 v[132:147], v[76:79], v[80:83], v[132:147]
    v_mov_b32 v10, 0
    v_mfma_f32_32x32x16_bf16 v[100:115], v[84:87], v[96:99], v[100:115]
    v_mfma_f32_32x32x16_bf16 v[116:131], v[88:91], v[96:99], v[116:131]
    s_waitcnt lgkmcnt(3)
    v_cndmask_b32 v148, v10, v8, s[58:59]
    v_cndmask_b32 v149, v10, v8, s[58:59]
    v_cndmask_b32 v150, v10, v8, s[58:59]
    v_cndmask_b32 v151, v10, v8, s[58:59]
    s_cmp_lt_u32 s57, 16
    s_cselect_b32 s49, 0x3eb8aa3b, 1.0
    v_mul_f32 v4, s49, v9
    s_cmp_lt_u32 s57, 15
    s_cselect_b32 s49, 0x3eb8aa3b, 1.0
    v_mul_f32 v5, s49, v9
    s_cmp_lt_u32 s57, 14
    s_cselect_b32 s49, 0x3eb8aa3b, 1.0
    v_mul_f32 v6, s49, v9
    v_mfma_f32_32x32x16_bf16 v[132:147], v[92:95], v[96:99], v[132:147]
    s_waitcnt lgkmcnt(0)
    v_mfma_f32_32x32x16_bf16 v[100:115], v[36:39], v[148:151], v[100:115]
    v_mfma_f32_32x32x16_bf16 v[116:131], v[40:43], v[148:151], v[116:131]
    v_mfma_f32_32x32x16_bf16 v[132:147], v[44:47], v[148:151], v[132:147]
    s_nop 8
    s_waitcnt lgkmcnt(0)
    v_mul_f32 v100, v100, v4
    v_mul_f32 v101, v101, v4
    v_mul_f32 v102, v102, v4
    v_mul_f32 v103, v103, v4
    v_mul_f32 v104, v104, v4
    v_mul_f32 v105, v105, v4
    v_mul_f32 v106, v106, v4
    v_mul_f32 v107, v107, v4
    v_cvt_pk_bf16_f32 v64, v100, v101
    v_cvt_pk_bf16_f32 v65, v102, v103
    v_cvt_pk_bf16_f32 v66, v104, v105
    v_cvt_pk_bf16_f32 v67, v106, v107
    s_add_u32 s49, s56, 0
    buffer_store_dwordx4 v[64:67], v160, s[20:23], s49 offen sc1
    v_mul_f32 v108, v108, v4
    v_mul_f32 v109, v109, v4
    v_mul_f32 v110, v110, v4
    v_mul_f32 v111, v111, v4
    v_mul_f32 v112, v112, v4
    v_mul_f32 v113, v113, v4
    v_mul_f32 v114, v114, v4
    v_mul_f32 v115, v115, v4
    v_cvt_pk_bf16_f32 v68, v108, v109
    v_cvt_pk_bf16_f32 v69, v110, v111
    v_cvt_pk_bf16_f32 v70, v112, v113
    v_cvt_pk_bf16_f32 v71, v114, v115
    s_add_u32 s49, s56, 65536
    buffer_store_dwordx4 v[68:71], v160, s[20:23], s49 offen sc1
    v_mul_f32 v116, v116, v5
    v_mul_f32 v117, v117, v5
    v_mul_f32 v118, v118, v5
    v_mul_f32 v119, v119, v5
    v_mul_f32 v120, v120, v5
    v_mul_f32 v121, v121, v5
    v_mul_f32 v122, v122, v5
    v_mul_f32 v123, v123, v5
    v_cvt_pk_bf16_f32 v72, v116, v117
    v_cvt_pk_bf16_f32 v73, v118, v119
    v_cvt_pk_bf16_f32 v74, v120, v121
    v_cvt_pk_bf16_f32 v75, v122, v123
    s_add_u32 s49, s56, 131072
    buffer_store_dwordx4 v[72:75], v161, s[20:23], s49 offen sc1
    v_mul_f32 v124, v124, v5
    v_mul_f32 v125, v125, v5
    v_mul_f32 v126, v126, v5
    v_mul_f32 v127, v127, v5
    v_mul_f32 v128, v128, v5
    v_mul_f32 v129, v129, v5
    v_mul_f32 v130, v130, v5
    v_mul_f32 v131, v131, v5
    v_cvt_pk_bf16_f32 v76, v124, v125
    v_cvt_pk_bf16_f32 v77, v126, v127
    v_cvt_pk_bf16_f32 v78, v128, v129
    v_cvt_pk_bf16_f32 v79, v130, v131
    s_add_u32 s49, s56, 196608
    buffer_store_dwordx4 v[76:79], v161, s[20:23], s49 offen sc1
    v_mul_f32 v132, v132, v6
    v_mul_f32 v133, v133, v6
    v_mul_f32 v134, v134, v6
    v_mul_f32 v135, v135, v6
    v_mul_f32 v136, v136, v6
    v_mul_f32 v137, v137, v6
    v_mul_f32 v138, v138, v6
    v_mul_f32 v139, v139, v6
    v_cvt_pk_bf16_f32 v80, v132, v133
    v_cvt_pk_bf16_f32 v81, v134, v135
    v_cvt_pk_bf16_f32 v82, v136, v137
    v_cvt_pk_bf16_f32 v83, v138, v139
    s_add_u32 s49, s56, 262144
    buffer_store_dwordx4 v[80:83], v162, s[20:23], s49 offen sc1
    v_mul_f32 v140, v140, v6
    v_mul_f32 v141, v141, v6
    v_mul_f32 v142, v142, v6
    v_mul_f32 v143, v143, v6
    v_mul_f32 v144, v144, v6
    v_mul_f32 v145, v145, v6
    v_mul_f32 v146, v146, v6
    v_mul_f32 v147, v147, v6
    v_cvt_pk_bf16_f32 v84, v140, v141
    v_cvt_pk_bf16_f32 v85, v142, v143
    v_cvt_pk_bf16_f32 v86, v144, v145
    v_cvt_pk_bf16_f32 v87, v146, v147
    s_add_u32 s49, s56, 327680
    buffer_store_dwordx4 v[84:87], v162, s[20:23], s49 offen sc1
    s_branch L_qkv_done
L_qkv1:
    s_waitcnt lgkmcnt(14)
    v_mfma_f32_32x32x16_bf16 v[100:115], v[36:39], v[48:51], v[100:115]
    ds_read_b128 v[96:99], v15
    ds_read_b64_tr_b16 v[84:85], v19 offset:0
    ds_read_b64_tr_b16 v[86:87], v19 offset:256
    v_mfma_f32_32x32x16_bf16 v[116:131], v[40:43], v[48:51], v[116:131]
    ds_read_b64_tr_b16 v[88:89], v19 offset:1024
    ds_read_b64_tr_b16 v[90:91], v19 offset:1280
    ds_read_b64_tr_b16 v[92:93], v19 offset:2048
    ds_read_b64_tr_b16 v[94:95], v19 offset:2304
    v_mfma_f32_32x32x16_bf16 v[132:147], v[48:51], v[44:47], v[132:147]
    v_smfmac_f32_16x16x64_bf16 v[28:31], v[20:23], v[36:43], v24
    v_smfmac_f32_16x16x64_bf16 v[32:35], v[20:23], v[44:51], v24
    s_cmp_eq_u32 s44, 7
    s_waitcnt lgkmcnt(14)
    v_mfma_f32_32x32x16_bf16 v[100:115], v[52:55], v[64:67], v[100:115]
    s_cbranch_scc1 L_qkv_x1
    s_cmp_eq_u32 s44, 4
    s_cselect_b32 s45, -65536, s52
    s_and_b32 s48, s44, 3
    s_cmp_eq_u32 s48, 3
    s_cselect_b32 s46, -36864, s42
    s_add_u32 s44, s44, 1
    v_add_u32 v12, s45, v12
    v_add_u32 v16, s46, v16
    v_add_u32 v13, s45, v13
    v_add_u32 v17, s46, v17
    v_mfma_f32_32x32x16_bf16 v[116:131], v[56:59], v[64:67], v[116:131]
    v_add_u32 v14, s45, v14
    v_add_u32 v18, s46, v18
    v_add_u32 v15, s45, v15
    v_add_u32 v19, s46, v19
    s_waitcnt lgkmcnt(0)
    v_mfma_f32_32x32x16_bf16 v[132:147], v[64:67], v[60:63], v[132:147]
    s_barrier
    v_mfma_f32_32x32x16_bf16 v[100:115], v[68:71], v[80:83], v[100:115]
    ds_read_b128 v[48:51], v12
    ds_read_b64_tr_b16 v[36:37], v16 offset:0
    ds_read_b64_tr_b16 v[38:39], v16 offset:256
    v_mfma_f32_32x32x16_bf16 v[116:131], v[72:75], v[80:83], v[116:131]
    ds_read_b64_tr_b16 v[40:41], v16 offset:1024
    ds_read_b64_tr_b16 v[42:43], v16 offset:1280
    ds_read_b64_tr_b16 v[44:45], v16 offset:2048
    ds_read_b64_tr_b16 v[46:47], v16 offset:2304
    v_mfma_f32_32x32x16_bf16 v[132:147], v[80:83], v[76:79], v[132:147]
    ds_read_b128 v[64:67], v13
    ds_read_b64_tr_b16 v[52:53], v17 offset:0
    ds_read_b64_tr_b16 v[54:55], v17 offset:256
    v_mfma_f32_32x32x16_bf16 v[100:115], v[84:87], v[96:99], v[100:115]
    ds_read_b64_tr_b16 v[56:57], v17 offset:1024
    ds_read_b64_tr_b16 v[58:59], v17 offset:1280
    ds_read_b64_tr_b16 v[60:61], v17 offset:2048
    ds_read_b64_tr_b16 v[62:63], v17 offset:2304
    v_mfma_f32_32x32x16_bf16 v[116:131], v[88:91], v[96:99], v[116:131]
    ds_read_b128 v[80:83], v14
    ds_read_b64_tr_b16 v[68:69], v18 offset:0
    ds_read_b64_tr_b16 v[70:71], v18 offset:256
    v_mfma_f32_32x32x16_bf16 v[132:147], v[96:99], v[92:95], v[132:147]
    ds_read_b64_tr_b16 v[72:73], v18 offset:1024
    ds_read_b64_tr_b16 v[74:75], v18 offset:1280
    ds_read_b64_tr_b16 v[76:77], v18 offset:2048
    ds_read_b64_tr_b16 v[78:79], v18 offset:2304
    s_branch L_qkv1
L_qkv_x1:
    v_mfma_f32_32x32x16_bf16 v[116:131], v[56:59], v[64:67], v[116:131]
    s_setprio 3
    v_mov_b32 v9, 100
    v_cmp_eq_u32 s[58:59], 0, v3
    s_nop 1
    v_add_f32 v4, v28, v29
    v_add_f32 v7, v32, v33
    v_mfma_f32_32x32x16_bf16 v[132:147], v[64:67], v[60:63], v[132:147]
    v_cvt_pk_bf16_f32 v6, v4, v4
    v_cvt_pk_bf16_f32 v10, v7, v7
    v_and_b32 v6, 0xffff0000, v6
    v_and_b32 v10, 0xffff0000, v10
    v_sub_f32 v6, v4, v6
    v_sub_f32 v10, v7, v10
    v_cvt_pk_bf16_f32 v6, v4, v6
    v_cvt_pk_bf16_f32 v10, v7, v10
    s_waitcnt lgkmcnt(0)
    ds_write_b32 v155, v6
    ds_write_b32 v155, v10 offset:1024
    ds_write_b32 v27, v9
    v_mfma_f32_32x32x16_bf16 v[100:115], v[68:71], v[80:83], v[100:115]
    v_mfma_f32_32x32x16_bf16 v[116:131], v[72:75], v[80:83], v[116:131]
L_e11:
    ds_read_b32 v8, v156 offset:0
    s_waitcnt lgkmcnt(0)
    v_cmp_gt_u32 vcc, 8, v8
    s_nop 0
    s_cbranch_vccz L_e11_ok
    s_sleep 1
    s_branch L_e11
L_e11_ok:
    ds_read_b64 v[8:9], v157
    ds_read_b128 v[36:39], v159 offset:0
    ds_read_b128 v[40:43], v159 offset:512
    ds_read_b128 v[44:47], v159 offset:1024
    ds_read2_b32 v[48:49], v158 offset0:1 offset1:3
    ds_read2_b32 v[50:51], v158 offset0:5 offset1:7
    ds_read2_b32 v[52:53], v158 offset0:17 offset1:19
    ds_read2_b32 v[54:55], v158 offset0:21 offset1:23
    ds_read2_b32 v[56:57], v158 offset0:33 offset1:35
    ds_read2_b32 v[58:59], v158 offset0:37 offset1:39
    ds_read2_b32 v[60:61], v158 offset0:49 offset1:51
    ds_read2_b32 v[62:63], v158 offset0:53 offset1:55
    v_mfma_f32_32x32x16_bf16 v[132:147], v[80:83], v[76:79], v[132:147]
    v_mov_b32 v10, 0
    v_mfma_f32_32x32x16_bf16 v[100:115], v[84:87], v[96:99], v[100:115]
    v_mfma_f32_32x32x16_bf16 v[116:131], v[88:91], v[96:99], v[116:131]
    s_waitcnt lgkmcnt(11)
    v_cndmask_b32 v148, v10, v8, s[58:59]
    v_cndmask_b32 v149, v10, v8, s[58:59]
    v_cndmask_b32 v150, v10, v8, s[58:59]
    v_cndmask_b32 v151, v10, v8, s[58:59]
    s_cmp_lt_u32 s57, 16
    s_cselect_b32 s49, 0x3eb8aa3b, 1.0
    v_mul_f32 v4, s49, v9
    s_cmp_lt_u32 s57, 15
    s_cselect_b32 s49, 0x3eb8aa3b, 1.0
    v_mul_f32 v5, s49, v9
    v_mfma_f32_32x32x16_bf16 v[132:147], v[96:99], v[92:95], v[132:147]
    s_waitcnt lgkmcnt(8)
    v_mfma_f32_32x32x16_bf16 v[100:115], v[36:39], v[148:151], v[100:115]
    v_mfma_f32_32x32x16_bf16 v[116:131], v[40:43], v[148:151], v[116:131]
    v_mfma_f32_32x32x16_bf16 v[132:147], v[148:151], v[44:47], v[132:147]
    s_nop 8
    s_waitcnt lgkmcnt(0)
    v_mul_f32 v100, v100, v4
    v_mul_f32 v101, v101, v4
    v_mul_f32 v102, v102, v4
    v_mul_f32 v103, v103, v4
    v_mul_f32 v104, v104, v4
    v_mul_f32 v105, v105, v4
    v_mul_f32 v106, v106, v4
    v_mul_f32 v107, v107, v4
    v_cvt_pk_bf16_f32 v64, v100, v101
    v_cvt_pk_bf16_f32 v65, v102, v103
    v_cvt_pk_bf16_f32 v66, v104, v105
    v_cvt_pk_bf16_f32 v67, v106, v107
    s_add_u32 s49, s56, 0
    buffer_store_dwordx4 v[64:67], v160, s[20:23], s49 offen sc1
    v_mul_f32 v108, v108, v4
    v_mul_f32 v109, v109, v4
    v_mul_f32 v110, v110, v4
    v_mul_f32 v111, v111, v4
    v_mul_f32 v112, v112, v4
    v_mul_f32 v113, v113, v4
    v_mul_f32 v114, v114, v4
    v_mul_f32 v115, v115, v4
    v_cvt_pk_bf16_f32 v68, v108, v109
    v_cvt_pk_bf16_f32 v69, v110, v111
    v_cvt_pk_bf16_f32 v70, v112, v113
    v_cvt_pk_bf16_f32 v71, v114, v115
    s_add_u32 s49, s56, 65536
    buffer_store_dwordx4 v[68:71], v160, s[20:23], s49 offen sc1
    v_mul_f32 v116, v116, v5
    v_mul_f32 v117, v117, v5
    v_mul_f32 v118, v118, v5
    v_mul_f32 v119, v119, v5
    v_mul_f32 v120, v120, v5
    v_mul_f32 v121, v121, v5
    v_mul_f32 v122, v122, v5
    v_mul_f32 v123, v123, v5
    v_cvt_pk_bf16_f32 v72, v116, v117
    v_cvt_pk_bf16_f32 v73, v118, v119
    v_cvt_pk_bf16_f32 v74, v120, v121
    v_cvt_pk_bf16_f32 v75, v122, v123
    s_add_u32 s49, s56, 131072
    buffer_store_dwordx4 v[72:75], v161, s[20:23], s49 offen sc1
    v_mul_f32 v124, v124, v5
    v_mul_f32 v125, v125, v5
    v_mul_f32 v126, v126, v5
    v_mul_f32 v127, v127, v5
    v_mul_f32 v128, v128, v5
    v_mul_f32 v129, v129, v5
    v_mul_f32 v130, v130, v5
    v_mul_f32 v131, v131, v5
    v_cvt_pk_bf16_f32 v76, v124, v125
    v_cvt_pk_bf16_f32 v77, v126, v127
    v_cvt_pk_bf16_f32 v78, v128, v129
    v_cvt_pk_bf16_f32 v79, v130, v131
    s_add_u32 s49, s56, 196608
    buffer_store_dwordx4 v[76:79], v161, s[20:23], s49 offen sc1
    v_mul_f32 v132, v132, v48
    v_mul_f32 v133, v133, v49
    v_mul_f32 v134, v134, v50
    v_mul_f32 v135, v135, v51
    v_mul_f32 v136, v136, v52
    v_mul_f32 v137, v137, v53
    v_mul_f32 v138, v138, v54
    v_mul_f32 v139, v139, v55
    v_cvt_pk_bf16_f32 v80, v132, v133
    v_cvt_pk_bf16_f32 v81, v134, v135
    v_cvt_pk_bf16_f32 v82, v136, v137
    v_cvt_pk_bf16_f32 v83, v138, v139
    s_add_u32 s49, s56, 262144
    buffer_store_dwordx4 v[80:83], v154, s[20:23], s49 offen offset:0 sc1
    v_mul_f32 v140, v140, v56
    v_mul_f32 v141, v141, v57
    v_mul_f32 v142, v142, v58
    v_mul_f32 v143, v143, v59
    v_mul_f32 v144, v144, v60
    v_mul_f32 v145, v145, v61
    v_mul_f32 v146, v146, v62
    v_mul_f32 v147, v147, v63
    v_cvt_pk_bf16_f32 v84, v140, v141
    v_cvt_pk_bf16_f32 v85, v142, v143
    v_cvt_pk_bf16_f32 v86, v144, v145
    v_cvt_pk_bf16_f32 v87, v146, v147
    buffer_store_dwordx4 v[84:87], v154, s[20:23], s49 offen offset:256 sc1
    s_branch L_qkv_done
L_qkv2:
    s_waitcnt lgkmcnt(14)
    v_mfma_f32_32x32x16_bf16 v[100:115], v[48:51], v[36:39], v[100:115]
    ds_read_b128 v[96:99], v15
    ds_read_b64_tr_b16 v[84:85], v19 offset:0
    ds_read_b64_tr_b16 v[86:87], v19 offset:256
    v_mfma_f32_32x32x16_bf16 v[116:131], v[48:51], v[40:43], v[116:131]
    ds_read_b64_tr_b16 v[88:89], v19 offset:1024
    ds_read_b64_tr_b16 v[90:91], v19 offset:1280
    ds_read_b64_tr_b16 v[92:93], v19 offset:2048
    ds_read_b64_tr_b16 v[94:95], v19 offset:2304
    v_mfma_f32_32x32x16_bf16 v[132:147], v[48:51], v[44:47], v[132:147]
    v_smfmac_f32_16x16x64_bf16 v[28:31], v[20:23], v[36:43], v24
    v_smfmac_f32_16x16x64_bf16 v[32:35], v[20:23], v[44:51], v24
    s_cmp_eq_u32 s44, 7
    s_waitcnt lgkmcnt(14)
    v_mfma_f32_32x32x16_bf16 v[100:115], v[64:67], v[52:55], v[100:115]
    s_cbranch_scc1 L_qkv_x2
    s_cmp_eq_u32 s44, 4
    s_cselect_b32 s45, -65536, s52
    s_and_b32 s48, s44, 3
    s_cmp_eq_u32 s48, 3
    s_cselect_b32 s46, -36864, s42
    s_add_u32 s44, s44, 1
    v_add_u32 v12, s45, v12
    v_add_u32 v16, s46, v16
    v_add_u32 v13, s45, v13
    v_add_u32 v17, s46, v17
    v_mfma_f32_32x32x16_bf16 v[116:131], v[64:67], v[56:59], v[116:131]
    v_add_u32 v14, s45, v14
    v_add_u32 v18, s46, v18
    v_add_u32 v15, s45, v15
    v_add_u32 v19, s46, v19
    s_waitcnt lgkmcnt(0)
    v_mfma_f32_32x32x16_bf16 v[132:147], v[64:67], v[60:63], v[132:147]
    s_barrier
    v_mfma_f32_32x32x16_bf16 v[100:115], v[80:83], v[68:71], v[100:115]
    ds_read_b128 v[48:51], v12
    ds_read_b64_tr_b16 v[36:37], v16 offset:0
    ds_read_b64_tr_b16 v[38:39], v16 offset:256
    v_mfma_f32_32x32x16_bf16 v[116:131], v[80:83], v[72:75], v[116:131]
    ds_read_b64_tr_b16 v[40:41], v16 offset:1024
    ds_read_b64_tr_b16 v[42:43], v16 offset:1280
    ds_read_b64_tr_b16 v[44:45], v16 offset:2048
    ds_read_b64_tr_b16 v[46:47], v16 offset:2304
    v_mfma_f32_32x32x16_bf16 v[132:147], v[80:83], v[76:79], v[132:147]
    ds_read_b128 v[64:67], v13
    ds_read_b64_tr_b16 v[52:53], v17 offset:0
    ds_read_b64_tr_b16 v[54:55], v17 offset:256
    v_mfma_f32_32x32x16_bf16 v[100:115], v[96:99], v[84:87], v[100:115]
    ds_read_b64_tr_b16 v[56:57], v17 offset:1024
    ds_read_b64_tr_b16 v[58:59], v17 offset:1280
    ds_read_b64_tr_b16 v[60:61], v17 offset:2048
    ds_read_b64_tr_b16 v[62:63], v17 offset:2304
    v_mfma_f32_32x32x16_bf16 v[116:131], v[96:99], v[88:91], v[116:131]
    ds_read_b128 v[80:83], v14
    ds_read_b64_tr_b16 v[68:69], v18 offset:0
    ds_read_b64_tr_b16 v[70:71], v18 offset:256
    v_mfma_f32_32x32x16_bf16 v[132:147], v[96:99], v[92:95], v[132:147]
    ds_read_b64_tr_b16 v[72:73], v18 offset:1024
    ds_read_b64_tr_b16 v[74:75], v18 offset:1280
    ds_read_b64_tr_b16 v[76:77], v18 offset:2048
    ds_read_b64_tr_b16 v[78:79], v18 offset:2304
    s_branch L_qkv2
L_qkv_x2:
    v_mfma_f32_32x32x16_bf16 v[116:131], v[64:67], v[56:59], v[116:131]
    s_setprio 3
    v_mov_b32 v9, 100
    v_cmp_eq_u32 s[58:59], 0, v3
    s_nop 1
    v_add_f32 v4, v28, v29
    v_add_f32 v7, v32, v33
    v_mfma_f32_32x32x16_bf16 v[132:147], v[64:67], v[60:63], v[132:147]
    v_cvt_pk_bf16_f32 v6, v4, v4
    v_cvt_pk_bf16_f32 v10, v7, v7
    v_and_b32 v6, 0xffff0000, v6
    v_and_b32 v10, 0xffff0000, v10
    v_sub_f32 v6, v4, v6
    v_sub_f32 v10, v7, v10
    v_cvt_pk_bf16_f32 v6, v4, v6
    v_cvt_pk_bf16_f32 v10, v7, v10
    s_waitcnt lgkmcnt(0)
    ds_write_b32 v155, v6
    ds_write_b32 v155, v10 offset:1024
    ds_write_b32 v27, v9
    v_mfma_f32_32x32x16_bf16 v[100:115], v[80:83], v[68:71], v[100:115]
    v_mfma_f32_32x32x16_bf16 v[116:131], v[80:83], v[72:75], v[116:131]
L_e12:
    ds_read_b32 v8, v156 offset:0
    s_waitcnt lgkmcnt(0)
    v_cmp_gt_u32 vcc, 8, v8
    s_nop 0
    s_cbranch_vccz L_e12_ok
    s_sleep 1
    s_branch L_e12
L_e12_ok:
    ds_read_b64 v[8:9], v157
    ds_read_b128 v[36:39], v159 offset:0
    ds_read_b128 v[40:43], v159 offset:512
    ds_read_b128 v[44:47], v159 offset:1024
    ds_read2_b32 v[48:49], v158 offset0:1 offset1:3
    ds_read2_b32 v[50:51], v158 offset0:5 offset1:7
    ds_read2_b32 v[52:53], v158 offset0:17 offset1:19
    ds_read2_b32 v[54:55], v158 offset0:21 offset1:23
    ds_read2_b32 v[56:57], v158 offset0:33 offset1:35
    ds_read2_b32 v[58:59], v158 offset0:37 offset1:39
    ds_read2_b32 v[60:61], v158 offset0:49 offset1:51
    ds_read2_b32 v[62:63], v158 offset0:53 offset1:55
    v_mfma_f32_32x32x16_bf16 v[132:147], v[80:83], v[76:79], v[132:147]
    v_mov_b32 v10, 0
    v_mfma_f32_32x32x16_bf16 v[100:115], v[96:99], v[84:87], v[100:115]
    v_mfma_f32_32x32x16_bf16 v[116:131], v[96:99], v[88:91], v[116:131]
    s_waitcnt lgkmcnt(11)
    v_cndmask_b32 v148, v10, v8, s[58:59]
    v_cndmask_b32 v149, v10, v8, s[58:59]
    v_cndmask_b32 v150, v10, v8, s[58:59]
    v_cndmask_b32 v151, v10, v8, s[58:59]
    v_mfma_f32_32x32x16_bf16 v[132:147], v[96:99], v[92:95], v[132:147]
    s_waitcnt lgkmcnt(8)
    v_mfma_f32_32x32x16_bf16 v[100:115], v[148:151], v[36:39], v[100:115]
    v_mfma_f32_32x32x16_bf16 v[116:131], v[148:151], v[40:43], v[116:131]
    v_mfma_f32_32x32x16_bf16 v[132:147], v[148:151], v[44:47], v[132:147]
    s_nop 8
    s_waitcnt lgkmcnt(0)
    v_mul_f32 v100, v100, v48
    v_mul_f32 v101, v101, v49
    v_mul_f32 v102, v102, v50
    v_mul_f32 v103, v103, v51
    v_mul_f32 v104, v104, v52
    v_mul_f32 v105, v105, v53
    v_mul_f32 v106, v106, v54
    v_mul_f32 v107, v107, v55
    v_cvt_pk_bf16_f32 v64, v100, v101
    v_cvt_pk_bf16_f32 v65, v102, v103
    v_cvt_pk_bf16_f32 v66, v104, v105
    v_cvt_pk_bf16_f32 v67, v106, v107
    s_add_u32 s49, s56, 0
    buffer_store_dwordx4 v[64:67], v154, s[20:23], s49 offen offset:0 sc1
    v_mul_f32 v108, v108, v56
    v_mul_f32 v109, v109, v57
    v_mul_f32 v110, v110, v58
    v_mul_f32 v111, v111, v59
    v_mul_f32 v112, v112, v60
    v_mul_f32 v113, v113, v61
    v_mul_f32 v114, v114, v62
    v_mul_f32 v115, v115, v63
    v_cvt_pk_bf16_f32 v68, v108, v109
    v_cvt_pk_bf16_f32 v69, v110, v111
    v_cvt_pk_bf16_f32 v70, v112, v113
    v_cvt_pk_bf16_f32 v71, v114, v115
    buffer_store_dwordx4 v[68:71], v154, s[20:23], s49 offen offset:256 sc1
    v_mul_f32 v116, v116, v48
    v_mul_f32 v117, v117, v49
    v_mul_f32 v118, v118, v50
    v_mul_f32 v119, v119, v51
    v_mul_f32 v120, v120, v52
    v_mul_f32 v121, v121, v53
    v_mul_f32 v122, v122, v54
    v_mul_f32 v123, v123, v55
    v_cvt_pk_bf16_f32 v72, v116, v117
    v_cvt_pk_bf16_f32 v73, v118, v119
    v_cvt_pk_bf16_f32 v74, v120, v121
    v_cvt_pk_bf16_f32 v75, v122, v123
    s_add_u32 s49, s56, 131072
    buffer_store_dwordx4 v[72:75], v154, s[20:23], s49 offen offset:0 sc1
    v_mul_f32 v124, v124, v56
    v_mul_f32 v125, v125, v57
    v_mul_f32 v126, v126, v58
    v_mul_f32 v127, v127, v59
    v_mul_f32 v128, v128, v60
    v_mul_f32 v129, v129, v61
    v_mul_f32 v130, v130, v62
    v_mul_f32 v131, v131, v63
    v_cvt_pk_bf16_f32 v76, v124, v125
    v_cvt_pk_bf16_f32 v77, v126, v127
    v_cvt_pk_bf16_f32 v78, v128, v129
    v_cvt_pk_bf16_f32 v79, v130, v131
    buffer_store_dwordx4 v[76:79], v154, s[20:23], s49 offen offset:256 sc1
    v_mul_f32 v132, v132, v48
    v_mul_f32 v133, v133, v49
    v_mul_f32 v134, v134, v50
    v_mul_f32 v135, v135, v51
    v_mul_f32 v136, v136, v52
    v_mul_f32 v137, v137, v53
    v_mul_f32 v138, v138, v54
    v_mul_f32 v139, v139, v55
    v_cvt_pk_bf16_f32 v80, v132, v133
    v_cvt_pk_bf16_f32 v81, v134, v135
    v_cvt_pk_bf16_f32 v82, v136, v137
    v_cvt_pk_bf16_f32 v83, v138, v139
    s_add_u32 s49, s56, 262144
    buffer_store_dwordx4 v[80:83], v154, s[20:23], s49 offen offset:0 sc1
    v_mul_f32 v140, v140, v56
    v_mul_f32 v141, v141, v57
    v_mul_f32 v142, v142, v58
    v_mul_f32 v143, v143, v59
    v_mul_f32 v144, v144, v60
    v_mul_f32 v145, v145, v61
    v_mul_f32 v146, v146, v62
    v_mul_f32 v147, v147, v63
    v_cvt_pk_bf16_f32 v84, v140, v141
    v_cvt_pk_bf16_f32 v85, v142, v143
    v_cvt_pk_bf16_f32 v86, v144, v145
    v_cvt_pk_bf16_f32 v87, v146, v147
    buffer_store_dwordx4 v[84:87], v154, s[20:23], s49 offen offset:256 sc1
L_qkv_done:
    s_cmp_lg_u32 s37, 0
    s_cbranch_scc1 L_nors
    s_lshl_b32 s49, s47, 7
    s_add_u32 s49, s49, 524288
    v_lshlrev_b32 v10, 2, v2
    buffer_store_dword v9, v10, s[20:23], s49 offen sc1
L_nors:
    s_add_u32 s18, s18, 1
    s_add_u32 s19, s19, 1
    s_lshl_b32 s51, s41, 3
    s_lshl_b32 s50, s39, 1
    s_add_u32 s51, s51, s50
    s_add_u32 s51, s51, s43
    s_lshl_b32 s50, s40, 6
    s_add_u32 s54, s50, s51
    s_xor_b32 s55, s54, 1
    s_lshl_b32 s54, s54, 10
    s_lshl_b32 s55, s55, 10
    s_add_u32 s54, s54, 1048576
    s_add_u32 s55, s55, 1048576
    s_lshl_b32 s48, s43, 12
    s_add_u32 s48, s48, 65536
    v_add_u32 v164, s48, v1
    v_and_b32 v5, 15, v0
    v_lshlrev_b32 v5, 4, v5
    v_lshl_add_u32 v7, v3, 9, v5
    s_add_u32 s48, s48, 8192
    v_add_u32 v7, s48, v7
    v_add_u32 v5, 160256, v5
    v_and_b32 v6, 16, v0
    v_cmp_eq_u32 vcc, 0, v6
    v_lshrrev_b32 v6, 4, v6
    v_xor_b32 v166, 1, v6
    v_cndmask_b32 v165, v5, v7, vcc
    v_mov_b32 v68, 0
    v_mov_b32 v69, 0
    v_mov_b32 v70, 0
    v_mov_b32 v71, 0
    v_mov_b32 v72, 0xdddd
    s_nop 0
    v_mfma_f32_32x32x16_bf16 v[36:51], v[68:71], v[68:71], 0
    v_mfma_f32_32x32x16_bf16 v[52:67], v[68:71], v[68:71], 0
    s_waitcnt vmcnt(0)
    v_mov_b32 v4, 1
    s_mov_b64 exec, 1
    ds_add_rtn_u32 v4, v167, v4 offset:56
    s_mov_b64 exec, -1
    v_lshrrev_b32 v5, 4, v0
    v_add_u32 v5, s57, v5
    v_lshrrev_b32 v6, 4, v5
    v_lshlrev_b32 v6, 7, v6
    v_and_b32 v5, 15, v5
    v_lshl_add_u32 v6, v5, 13, v6
    v_and_b32 v5, 15, v0
    v_lshl_add_u32 v6, v5, 9, v6
    s_lshl_b32 s48, s36, 3
    v_add_u32 v6, s48, v6
    s_waitcnt lgkmcnt(0)
    v_readfirstlane_b32 s49, v4
    s_nop 0
    s_cmp_lg_u32 s49, 3
    s_cbranch_scc1 L_f1a
    v_mov_b32 v4, s18
    v_mov_b32 v5, s19
    s_mov_b32 s48, 65536
    s_mov_b32 exec_hi, 0xffff
    buffer_store_dwordx2 v[4:5], v6, s[20:23], s48 offen sc1
    s_mov_b64 exec, -1
L_f1a:
    s_setprio 1
    v_mov_b32 v4, 1
    s_mov_b64 exec, 1
    ds_add_rtn_u32 v4, v167, v4 offset:52
    s_mov_b64 exec, -1
    s_lshr_b32 s48, s36, 1
    s_lshl_b32 s48, s48, 9
    s_and_b32 s49, s36, 1
    s_add_u32 s49, s49, 1
    s_lshl_b32 s49, s49, 7
    s_add_u32 s48, s48, s49
    v_lshl_add_u32 v6, v0, 12, s48
    s_lshl_b32 s48, s36, 13
    v_and_b32 v5, 15, v0
    v_cmp_gt_u32 vcc, 32, v0
    v_lshl_add_u32 v5, v5, 9, s48
    s_lshl_b32 s48, s37, 3
    v_cndmask_b32 v6, v5, v6, vcc
    v_add_u32 v6, s48, v6
    s_waitcnt lgkmcnt(0)
    v_readfirstlane_b32 s49, v4
    s_nop 0
    s_cmp_lg_u32 s49, 11
    s_cbranch_scc1 L_f2a
    v_mov_b32 v4, s18
    v_mov_b32 v5, s19
    s_mov_b32 s48, 196608
    s_mov_b32 exec_hi, 0xffff
    buffer_store_dwordx2 v[4:5], v6, s[20:23], s48 offen sc1
    s_mov_b64 exec, -1
L_f2a:
    s_mov_b32 s56, 0
    s_cmp_lg_u32 s39, 0
    s_cbranch_scc1 L_attnq
    s_lshl_b32 s50, s40, 3
    s_add_u32 s50, s50, s41
    s_lshl_b32 s50, s50, 9
    s_add_u32 s50, s50, 65536
    v_lshlrev_b32 v6, 3, v0
    s_lshl_b32 s48, s41, 1
    s_lshl_b32 s52, 3, s48
    s_or_b32 s52, s52, 50528256
    s_mov_b32 s53, 771
    s_mov_b32 s58, 200000
    s_mov_b64 exec, s[52:53]
L_pq:
    buffer_load_dwordx2 v[4:5], v6, s[20:23], s50 offen sc1
    s_waitcnt vmcnt(0)
    v_xor_b32 v4, s18, v4
    v_xor_b32 v5, s19, v5
    v_or_b32 v4, v4, v5
    v_cmp_ne_u32 vcc, 0, v4
    s_sub_u32 s58, s58, 1
    s_cbranch_scc1 L_pq_ok
    s_cbranch_vccz L_pq_ok
    s_sleep 8
    s_branch L_pq
L_pq_ok:
    s_mov_b64 exec, -1
    v_mov_b32 v4, 1
    v_mov_b32 v5, 150588
    ds_write_b32 v5, v4
    s_branch L_attnq
L_stats0:
    s_setprio 2
    v_mov_b32 v7, 0x3f803f80
    v_and_b32 v5, 11, v0
    v_cmp_eq_u32 vcc, 0, v5
    s_lshl_b32 s48, s39, 10
    s_add_u32 s48, s48, 160256
    v_cndmask_b32 v36, v8, v7, vcc
    v_add_u32 v5, s48, v1
    v_min_u32 v5, 163584, v5
    v_and_b32 v6, 0xf0, v1
    v_or_b32 v5, v5, v6
    v_mov_b32 v37, v36
    v_mov_b32 v38, v36
    v_mov_b32 v39, v36
    ds_write_b128 v5, v[36:39]
    s_waitcnt lgkmcnt(0)
    s_add_u32 s18, s18, 1
    s_add_u32 s19, s19, 1
    s_lshl_b32 s51, s41, 3
    s_lshl_b32 s50, s39, 1
    s_add_u32 s51, s51, s50
    s_add_u32 s51, s51, s43
    s_lshl_b32 s50, s40, 6
    s_add_u32 s54, s50, s51
    s_xor_b32 s55, s54, 1
    s_lshl_b32 s54, s54, 10
    s_lshl_b32 s55, s55, 10
    s_add_u32 s54, s54, 1048576
    s_add_u32 s55, s55, 1048576
    s_lshl_b32 s48, s43, 12
    s_add_u32 s48, s48, 65536
    v_add_u32 v164, s48, v1
    v_and_b32 v5, 15, v0
    v_lshlrev_b32 v5, 4, v5
    v_lshl_add_u32 v7, v3, 9, v5
    s_add_u32 s48, s48, 8192
    v_add_u32 v7, s48, v7
    v_add_u32 v5, 160256, v5
    v_and_b32 v6, 16, v0
    v_cmp_eq_u32 vcc, 0, v6
    v_lshrrev_b32 v6, 4, v6
    v_xor_b32 v166, 1, v6
    v_cndmask_b32 v165, v5, v7, vcc
L_stats:
    s_barrier
    ds_read_b128 v[36:39], v12
    ds_read_b128 v[40:43], v13
    ds_read_b128 v[44:47], v14
    ds_read_b128 v[48:51], v15
    s_cmp_eq_u32 s44, 4
    s_cselect_b32 s45, -65536, s52
    s_and_b32 s48, s44, 3
    s_cmp_eq_u32 s48, 3
    s_cselect_b32 s46, -36864, s42
    s_add_u32 s44, s44, 1
    v_add_u32 v12, s45, v12
    v_add_u32 v13, s45, v13
    v_add_u32 v14, s45, v14
    v_add_u32 v15, s45, v15
    s_waitcnt lgkmcnt(2)
    v_smfmac_f32_16x16x64_bf16 v[28:31], v[20:23], v[36:43], v24
    s_waitcnt lgkmcnt(0)
    v_smfmac_f32_16x16x64_bf16 v[28:31], v[20:23], v[44:51], v24
    v_dot2c_f32_bf16 v25, v36, v36
    v_dot2c_f32_bf16 v25, v37, v37
    v_dot2c_f32_bf16 v25, v38, v38
    v_dot2c_f32_bf16 v25, v39, v39
    v_dot2c_f32_bf16 v25, v40, v40
    v_dot2c_f32_bf16 v25, v41, v41
    v_dot2c_f32_bf16 v25, v42, v42
    v_dot2c_f32_bf16 v25, v43, v43
    v_dot2c_f32_bf16 v25, v44, v44
    v_dot2c_f32_bf16 v25, v45, v45
    v_dot2c_f32_bf16 v25, v46, v46
    v_dot2c_f32_bf16 v25, v47, v47
    v_dot2c_f32_bf16 v25, v48, v48
    v_dot2c_f32_bf16 v25, v49, v49
    v_dot2c_f32_bf16 v25, v50, v50
    v_dot2c_f32_bf16 v25, v51, v51
    s_cmp_lt_u32 s44, 8
    s_cbranch_scc1 L_stats
    s_waitcnt lgkmcnt(0)
    s_lshl_b32 s48, s39, 8
    s_add_u32 s48, s48, 149504
    v_lshl_add_u32 v7, v2, 3, s48
    v_mov_b32 v10, v25
    v_add_f32 v8, v28, v29
    v_mov_b32 v6, v10
    v_mov_b32 v9, v8
    s_lshr_b32 s49, s39, 1
    s_and_b32 s56, s39, 1
    v_permlane32_swap_b32 v10, v6
    v_permlane32_swap_b32 v8, v9
    s_nop 0
    v_add_f32 v10, v10, v6
    v_add_f32 v8, v8, v9
    v_mov_b32 v6, 0x3b000000
    v_mul_f32 v8, 0xbb000000, v8
    v_mul_f32 v9, v8, v8
    v_fma_f32 v10, v10, v6, -v9
    v_max_f32 v10, 0, v10
    v_cvt_pk_bf16_f32 v10, v10, v10
    v_and_b32 v10, 0xffff0000, v10
    v_add_f32 v10, 0x3727c5ac, v10
    v_cvt_pk_bf16_f32 v10, v10, v10
    v_and_b32 v10, 0xffff0000, v10
    v_sqrt_f32 v10, v10
    v_cvt_pk_bf16_f32 v8, v8, v8
    v_cvt_pk_bf16_f32 v10, v10, v10
    v_and_b32 v10, 0xffff0000, v10
    v_rcp_f32 v9, v10
    s_lshl_b32 s57, s49, 13
    s_add_u32 s57, s57, 32768
    ds_write_b64 v7, v[8:9]
    s_cmp_ge_u32 s37, 14
    s_cselect_b32 s58, 17, 8
    v_mov_b32 v9, s58
    ds_write_b32 v27, v9
    s_cbranch_scc1 L_b_idle
    s_setprio 0
    s_lshl_b32 s58, s56, 11
    s_add_u32 s58, s58, 81920
    s_lshl_b32 s59, s49, 1
    v_add_u32 v5, s57, v4
    s_add_u32 s48, s59, 0
    s_and_b32 s48, s48, 3
    s_lshl_b32 s50, s48, 5
    v_xor_b32 v12, s50, v5
    s_mul_i32 s48, s48, 4096
    s_add_u32 s48, s48, s58
    v_add_u32 v16, s48, v11
    s_add_u32 s48, s59, 1
    s_and_b32 s48, s48, 3
    s_lshl_b32 s50, s48, 5
    v_xor_b32 v13, s50, v5
    s_mul_i32 s48, s48, 4096
    s_add_u32 s48, s48, s58
    v_add_u32 v17, s48, v11
    s_add_u32 s48, s59, 2
    s_and_b32 s48, s48, 3
    s_lshl_b32 s50, s48, 5
    v_xor_b32 v14, s50, v5
    s_mul_i32 s48, s48, 4096
    s_add_u32 s48, s48, s58
    v_add_u32 v18, s48, v11
    s_add_u32 s48, s59, 3
    s_and_b32 s48, s48, 3
    s_lshl_b32 s50, s48, 5
    v_xor_b32 v15, s50, v5
    s_mul_i32 s48, s48, 4096
    s_add_u32 s48, s48, s58
    v_add_u32 v19, s48, v11
    s_mov_b32 s44, 8
L_b_f8:
    ds_read_b32 v8, v167 offset:0
    s_waitcnt lgkmcnt(0)
    v_cmp_gt_u32 vcc, 9, v8
    s_nop 0
    s_cbranch_vccz L_b_f8_ok
    s_sleep 1
    s_branch L_b_f8
L_b_f8_ok:
    ds_read_b128 v[44:47], v12
    ds_read_b64_tr_b16 v[36:37], v16 offset:0
    ds_read_b64_tr_b16 v[38:39], v16 offset:256
    ds_read_b128 v[48:51], v12 offset:4096
    ds_read_b64_tr_b16 v[40:41], v16 offset:1024
    ds_read_b64_tr_b16 v[42:43], v16 offset:1280
    ds_read_b128 v[60:63], v13
    ds_read_b64_tr_b16 v[52:53], v17 offset:0
    ds_read_b64_tr_b16 v[54:55], v17 offset:256
    ds_read_b128 v[64:67], v13 offset:4096
    ds_read_b64_tr_b16 v[56:57], v17 offset:1024
    ds_read_b64_tr_b16 v[58:59], v17 offset:1280
    ds_read_b128 v[76:79], v14
    ds_read_b64_tr_b16 v[68:69], v18 offset:0
    ds_read_b64_tr_b16 v[70:71], v18 offset:256
    ds_read_b128 v[80:83], v14 offset:4096
    ds_read_b64_tr_b16 v[72:73], v18 offset:1024
    ds_read_b64_tr_b16 v[74:75], v18 offset:1280
    ds_read_b128 v[92:95], v15
    ds_read_b64_tr_b16 v[84:85], v19 offset:0
    ds_read_b64_tr_b16 v[86:87], v19 offset:256
L_ffn1:
    s_waitcnt lgkmcnt(15)
    v_mfma_f32_32x32x16_bf16 v[100:115], v[36:39], v[44:47], v[100:115]
    ds_read_b128 v[96:99], v15 offset:4096
    ds_read_b64_tr_b16 v[88:89], v19 offset:1024
    ds_read_b64_tr_b16 v[90:91], v19 offset:1280
    ds_read_b32 v8, v167
    v_mfma_f32_32x32x16_bf16 v[132:147], v[36:39], v[48:51], v[132:147]
    v_mfma_f32_32x32x16_bf16 v[116:131], v[40:43], v[44:47], v[116:131]
    v_mfma_f32_32x32x16_bf16 v[148:163], v[40:43], v[48:51], v[148:163]
    v_smfmac_f32_16x16x64_bf16 v[32:35], v[20:23], v[36:43], v24
    s_cmp_eq_u32 s44, 15
    s_waitcnt lgkmcnt(13)
    v_mfma_f32_32x32x16_bf16 v[100:115], v[52:55], v[60:63], v[100:115]
    s_cbranch_scc1 L_ffn1_x
    s_cmp_eq_u32 s44, 10
    s_cselect_b32 s45, 65536, s53
    s_and_b32 s48, s44, 3
    s_cmp_eq_u32 s48, 3
    s_cselect_b32 s46, -49152, s52
    s_add_u32 s44, s44, 1
    s_add_u32 s49, s44, 1
    v_mov_b32 v9, s44
    v_mfma_f32_32x32x16_bf16 v[132:147], v[52:55], v[64:67], v[132:147]
    v_add_u32 v12, s45, v12
    v_add_u32 v16, s46, v16
    v_add_u32 v13, s45, v13
    v_add_u32 v17, s46, v17
    v_smfmac_f32_16x16x64_bf16 v[32:35], v[20:23], v[52:59], v24
    v_add_u32 v14, s45, v14
    v_add_u32 v18, s46, v18
    v_add_u32 v15, s45, v15
    v_add_u32 v19, s46, v19
    v_mfma_f32_32x32x16_bf16 v[116:131], v[56:59], v[60:63], v[116:131]
    s_waitcnt lgkmcnt(0)
    ds_write_b32 v27, v9
    v_cmp_gt_u32 vcc, s49, v8
    v_mfma_f32_32x32x16_bf16 v[148:163], v[56:59], v[64:67], v[148:163]
    s_cbranch_vccnz L_ffn1_s
L_ffn1_b:
    v_mfma_f32_32x32x16_bf16 v[100:115], v[68:71], v[76:79], v[100:115]
    ds_read_b128 v[44:47], v12
    ds_read_b64_tr_b16 v[36:37], v16 offset:0
    ds_read_b64_tr_b16 v[38:39], v16 offset:256
    v_mfma_f32_32x32x16_bf16 v[132:147], v[68:71], v[80:83], v[132:147]
    ds_read_b128 v[48:51], v12 offset:4096
    ds_read_b64_tr_b16 v[40:41], v16 offset:1024
    ds_read_b64_tr_b16 v[42:43], v16 offset:1280
    v_mfma_f32_32x32x16_bf16 v[116:131], v[72:75], v[76:79], v[116:131]
    ds_read_b128 v[60:63], v13
    ds_read_b64_tr_b16 v[52:53], v17 offset:0
    ds_read_b64_tr_b16 v[54:55], v17 offset:256
    v_mfma_f32_32x32x16_bf16 v[148:163], v[72:75], v[80:83], v[148:163]
    ds_read_b128 v[64:67], v13 offset:4096
    ds_read_b64_tr_b16 v[56:57], v17 offset:1024
    ds_read_b64_tr_b16 v[58:59], v17 offset:1280
    v_mfma_f32_32x32x16_bf16 v[100:115], v[84:87], v[92:95], v[100:115]
    ds_read_b128 v[76:79], v14
    ds_read_b64_tr_b16 v[68:69], v18 offset:0
    ds_read_b64_tr_b16 v[70:71], v18 offset:256
    v_mfma_f32_32x32x16_bf16 v[132:147], v[84:87], v[96:99], v[132:147]
    ds_read_b128 v[80:83], v14 offset:4096
    ds_read_b64_tr_b16 v[72:73], v18 offset:1024
    ds_read_b64_tr_b16 v[74:75], v18 offset:1280
    v_mfma_f32_32x32x16_bf16 v[116:131], v[88:91], v[92:95], v[116:131]
    v_mfma_f32_32x32x16_bf16 v[148:163], v[88:91], v[96:99], v[148:163]
    ds_read_b128 v[92:95], v15
    ds_read_b64_tr_b16 v[84:85], v19 offset:0
    ds_read_b64_tr_b16 v[86:87], v19 offset:256
    s_branch L_ffn1
L_ffn1_s:
L_ffn1_sw:
    ds_read_b32 v8, v167 offset:0
    s_waitcnt lgkmcnt(0)
    v_cmp_gt_u32 vcc, s49, v8
    s_nop 0
    s_cbranch_vccz L_ffn1_sw_ok
    s_sleep 1
    s_branch L_ffn1_sw
L_ffn1_sw_ok:
    s_branch L_ffn1_b
L_ffn1_x:
    v_smfmac_f32_16x16x64_bf16 v[32:35], v[20:23], v[52:59], v24
    v_mfma_f32_32x32x16_bf16 v[132:147], v[52:55], v[64:67], v[132:147]
    s_lshr_b32 s49, s39, 1
    s_lshl_b32 s48, s56, 10
    s_add_u32 s48, s48, 147456
    s_lshl_b32 s57, s49, 2
    s_add_u32 s57, s57, s48
    v_add_u32 v5, s57, v1
    v_mov_b32 v9, 16
    v_mfma_f32_32x32x16_bf16 v[116:131], v[56:59], v[60:63], v[116:131]
    v_add_f32 v4, v32, v33
    v_cvt_pk_bf16_f32 v6, v4, v4
    v_and_b32 v6, 0xffff0000, v6
    v_sub_f32 v6, v4, v6
    v_cvt_pk_bf16_f32 v6, v4, v6
    v_mfma_f32_32x32x16_bf16 v[148:163], v[56:59], v[64:67], v[148:163]
    s_waitcnt lgkmcnt(0)
    ds_write_b32 v5, v6
    ds_write_b32 v27, v9
    v_mfma_f32_32x32x16_bf16 v[100:115], v[68:71], v[76:79], v[100:115]
    v_lshl_add_u32 v5, v2, 4, s48
    s_lshl_b32 s57, s49, 9
    s_add_u32 s57, s57, 149504
    v_lshl_add_u32 v7, v2, 3, s57
    v_add_u32 v4, 32, v167
    v_mfma_f32_32x32x16_bf16 v[132:147], v[68:71], v[80:83], v[132:147]
    s_lshl_b32 s57, s36, 2
    s_lshl_b32 s58, s49, 1
    s_add_u32 s57, s57, s58
    s_mul_i32 s52, s57, 112
    s_lshl_b32 s57, s37, 3
    s_add_u32 s52, s52, s57
    s_lshl_b32 s57, s56, 2
    s_add_u32 s52, s52, s57
    s_lshl_b32 s52, s52, 10
    s_add_u32 s52, s52, 7340032
    s_add_u32 s53, s52, 114688
    v_mfma_f32_32x32x16_bf16 v[116:131], v[72:75], v[76:79], v[116:131]
    v_mfma_f32_32x32x16_bf16 v[148:163], v[72:75], v[80:83], v[148:163]
L_e2:
    ds_read_b32 v8, v4 offset:0
    s_waitcnt lgkmcnt(0)
    v_cmp_gt_u32 vcc, 16, v8
    s_nop 0
    s_cbranch_vccz L_e2_ok
    s_sleep 1
    s_branch L_e2
L_e2_ok:
    ds_read_b32 v8, v7
    ds_read_b32 v9, v7 offset:256
    ds_read_b64 v[44:45], v5
    ds_read_b64 v[48:49], v5 offset:512
    v_mfma_f32_32x32x16_bf16 v[100:115], v[84:87], v[92:95], v[100:115]
    v_cmp_eq_u32 vcc, 0, v3
    v_mov_b32 v10, 0
    v_mov_b32 v46, 0
    v_mov_b32 v47, 0
    v_mov_b32 v50, 0
    v_mov_b32 v51, 0
    v_mfma_f32_32x32x16_bf16 v[132:147], v[84:87], v[96:99], v[132:147]
    v_mov_b32 v38, 0
    v_mov_b32 v39, 0
    v_mov_b32 v42, 0
    v_mov_b32 v43, 0
    s_waitcnt lgkmcnt(2)
    v_mfma_f32_32x32x16_bf16 v[116:131], v[88:91], v[92:95], v[116:131]
    v_cndmask_b32 v36, v10, v8, vcc
    v_cndmask_b32 v37, v10, v8, vcc
    v_cndmask_b32 v40, v10, v9, vcc
    v_cndmask_b32 v41, v10, v9, vcc
    v_mfma_f32_32x32x16_bf16 v[148:163], v[88:91], v[96:99], v[148:163]
    v_mov_b32 v9, 150588
    s_waitcnt lgkmcnt(0)
    v_mfma_f32_32x32x16_bf16 v[100:115], v[44:47], v[36:39], v[100:115]
    v_mfma_f32_32x32x16_bf16 v[116:131], v[48:51], v[36:39], v[116:131]
    v_mfma_f32_32x32x16_bf16 v[132:147], v[44:47], v[40:43], v[132:147]
    v_mfma_f32_32x32x16_bf16 v[148:163], v[48:51], v[40:43], v[148:163]
L_b_q:
    ds_read_b32 v8, v9 offset:0
    s_waitcnt lgkmcnt(0)
    v_cmp_gt_u32 vcc, 1, v8
    s_nop 0
    s_cbranch_vccz L_b_q_ok
    s_sleep 1
    s_branch L_b_q
L_b_q_ok:
    buffer_load_dwordx4 v[76:79], v1, s[20:23], s54 offen sc1
    buffer_load_dwordx4 v[80:83], v1, s[20:23], s55 offen sc1
    v_mov_b32 v68, 0
    v_mov_b32 v69, 0
    v_mov_b32 v70, 0
    v_mov_b32 v71, 0
    v_mov_b32 v72, 0xdddd
    s_nop 0
    v_mfma_f32_32x32x16_bf16 v[36:51], v[68:71], v[68:71], 0
    v_mfma_f32_32x32x16_bf16 v[52:67], v[68:71], v[68:71], 0
    v_mov_b32 v73, v27
    v_cvt_pk_bf16_f32 v4, v100, v101
    v_cvt_pk_bf16_f32 v5, v102, v103
    v_cvt_pk_bf16_f32 v6, v104, v105
    v_cvt_pk_bf16_f32 v7, v106, v107
    v_cvt_pk_bf16_f32 v8, v108, v109
    v_cvt_pk_bf16_f32 v9, v110, v111
    v_cvt_pk_bf16_f32 v10, v112, v113
    v_cvt_pk_bf16_f32 v11, v114, v115
    v_pk_max_i16 v4, v4, 0
    v_pk_max_i16 v5, v5, 0
    v_pk_max_i16 v6, v6, 0
    v_pk_max_i16 v7, v7, 0
    v_pk_max_i16 v8, v8, 0
    v_pk_max_i16 v9, v9, 0
    v_pk_max_i16 v10, v10, 0
    v_pk_max_i16 v11, v11, 0
    buffer_store_dwordx4 v[4:7], v1, s[20:23], s52 offen offset:0 sc1
    buffer_store_dwordx4 v[8:11], v1, s[20:23], s52 offen offset:1024 sc1
    v_cvt_pk_bf16_f32 v12, v116, v117
    v_cvt_pk_bf16_f32 v13, v118, v119
    v_cvt_pk_bf16_f32 v14, v120, v121
    v_cvt_pk_bf16_f32 v15, v122, v123
    v_cvt_pk_bf16_f32 v16, v124, v125
    v_cvt_pk_bf16_f32 v17, v126, v127
    v_cvt_pk_bf16_f32 v18, v128, v129
    v_cvt_pk_bf16_f32 v19, v130, v131
    v_pk_max_i16 v12, v12, 0
    v_pk_max_i16 v13, v13, 0
    v_pk_max_i16 v14, v14, 0
    v_pk_max_i16 v15, v15, 0
    v_pk_max_i16 v16, v16, 0
    v_pk_max_i16 v17, v17, 0
    v_pk_max_i16 v18, v18, 0
    v_pk_max_i16 v19, v19, 0
    buffer_store_dwordx4 v[12:15], v1, s[20:23], s52 offen offset:2048 sc1
    buffer_store_dwordx4 v[16:19], v1, s[20:23], s52 offen offset:3072 sc1
    v_cvt_pk_bf16_f32 v20, v132, v133
    v_cvt_pk_bf16_f32 v21, v134, v135
    v_cvt_pk_bf16_f32 v22, v136, v137
    v_cvt_pk_bf16_f32 v23, v138, v139
    v_cvt_pk_bf16_f32 v24, v140, v141
    v_cvt_pk_bf16_f32 v25, v142, v143
    v_cvt_pk_bf16_f32 v26, v144, v145
    v_cvt_pk_bf16_f32 v27, v146, v147
    v_pk_max_i16 v20, v20, 0
    v_pk_max_i16 v21, v21, 0
    v_pk_max_i16 v22, v22, 0
    v_pk_max_i16 v23, v23, 0
    v_pk_max_i16 v24, v24, 0
    v_pk_max_i16 v25, v25, 0
    v_pk_max_i16 v26, v26, 0
    v_pk_max_i16 v27, v27, 0
    buffer_store_dwordx4 v[20:23], v1, s[20:23], s53 offen offset:0 sc1
    buffer_store_dwordx4 v[24:27], v1, s[20:23], s53 offen offset:1024 sc1
    v_cvt_pk_bf16_f32 v28, v148, v149
    v_cvt_pk_bf16_f32 v29, v150, v151
    v_cvt_pk_bf16_f32 v30, v152, v153
    v_cvt_pk_bf16_f32 v31, v154, v155
    v_cvt_pk_bf16_f32 v32, v156, v157
    v_cvt_pk_bf16_f32 v33, v158, v159
    v_cvt_pk_bf16_f32 v34, v160, v161
    v_cvt_pk_bf16_f32 v35, v162, v163
    v_pk_max_i16 v28, v28, 0
    v_pk_max_i16 v29, v29, 0
    v_pk_max_i16 v30, v30, 0
    v_pk_max_i16 v31, v31, 0
    v_pk_max_i16 v32, v32, 0
    v_pk_max_i16 v33, v33, 0
    v_pk_max_i16 v34, v34, 0
    v_pk_max_i16 v35, v35, 0
    buffer_store_dwordx4 v[28:31], v1, s[20:23], s53 offen offset:2048 sc1
    buffer_store_dwordx4 v[32:35], v1, s[20:23], s53 offen offset:3072 sc1
    v_mov_b32 v2, 17
    ds_write_b32 v73, v2
    s_mov_b32 s56, 1
    s_setprio 3
L_b_kv0:
    ds_read_b32 v2, v167 offset:64
    s_waitcnt lgkmcnt(0)
    v_cmp_gt_u32 vcc, 1, v2
    s_nop 0
    s_cbranch_vccz L_b_kv0_ok
    s_sleep 1
    s_branch L_b_kv0
L_b_kv0_ok:
    s_waitcnt vmcnt(8)
    s_branch L_attn
L_b_idle:
    v_mov_b32 v68, 0
    v_mov_b32 v69, 0
    v_mov_b32 v70, 0
    v_mov_b32 v71, 0
    v_mov_b32 v72, 0xdddd
    s_nop 0
    v_mfma_f32_32x32x16_bf16 v[36:51], v[68:71], v[68:71], 0
    v_mfma_f32_32x32x16_bf16 v[52:67], v[68:71], v[68:71], 0
    s_mov_b32 s56, 1
L_attnq:
    v_mov_b32 v9, 150588
L_a_q:
    ds_read_b32 v8, v9 offset:0
    s_waitcnt lgkmcnt(0)
    v_cmp_gt_u32 vcc, 1, v8
    s_nop 0
    s_cbranch_vccz L_a_q_ok
    s_sleep 1
    s_branch L_a_q
L_a_q_ok:
    buffer_load_dwordx4 v[76:79], v1, s[20:23], s54 offen sc1
    buffer_load_dwordx4 v[80:83], v1, s[20:23], s55 offen sc1
L_kv0:
    ds_read_b32 v2, v167 offset:64
    s_waitcnt lgkmcnt(0)
    v_cmp_gt_u32 vcc, 1, v2
    s_nop 0
    s_cbranch_vccz L_kv0_ok
    s_sleep 1
    s_branch L_kv0
L_kv0_ok:
    s_setprio 0
    s_waitcnt vmcnt(0)
L_attn:
    s_lshl_b32 s45, s43, 11
    s_sub_u32 s45, 85248, s45
    v_add_u32 v2, s45, v164
    s_mul_i32 s45, s43, 3072
    s_sub_u32 s45, 81152, s45
    v_mad_i32_i24 v3, v166, s45, v165
    ds_read_b128 v[140:143], v2
    ds_read_b128 v[148:151], v3
    ds_read_b128 v[152:155], v3 offset:256
    ds_read_b128 v[160:163], v3 offset:256
    ds_read_b128 v[144:147], v2 offset:1024
    v_mfma_f32_32x32x16_bf16 v[116:131], v[68:71], v[68:71], 0
    s_mov_b32 s44, 0
    s_mov_b32 s45, -16384
    s_mov_b32 s46, 16384
    s_waitcnt lgkmcnt(4)
    v_mfma_f32_32x32x16_bf16 v[100:115], v[140:143], v[76:79], 0
    s_nop 9
    s_branch L_itb
L_aloop:
    s_bitcmp1_b32 0x9e, s44
    s_cbranch_scc1 L_itx
L_itb:
    s_waitcnt lgkmcnt(0)
    v_exp_f32 v100, v100
    v_exp_f32 v101, v101
    v_smfmac_f32_32x32x32_bf16 v[52:67], v[160:163], v[124:131], v72
    v_exp_f32 v102, v102
    ds_read_b128 v[156:159], v165 offset:0
    v_exp_f32 v103, v103
    v_exp_f32 v104, v104
    v_exp_f32 v105, v105
    v_mfma_f32_32x32x16_bf16 v[116:131], v[140:143], v[80:83], 0
    v_exp_f32 v106, v106
    ds_read_b128 v[160:163], v165 offset:256
    v_exp_f32 v107, v107
    v_exp_f32 v108, v108
    v_exp_f32 v109, v109
    v_smfmac_f32_32x32x32_bf16 v[36:51], v[148:151], v[100:107], v72
    v_exp_f32 v110, v110
    ds_read_b128 v[140:143], v164 offset:0
    v_exp_f32 v111, v111
    v_exp_f32 v112, v112
    v_exp_f32 v113, v113
    v_exp_f32 v114, v114
    v_exp_f32 v115, v115
    v_exp_f32 v116, v116
    v_exp_f32 v117, v117
    v_smfmac_f32_32x32x32_bf16 v[36:51], v[152:155], v[108:115], v72
    v_exp_f32 v118, v118
    v_exp_f32 v119, v119
    v_exp_f32 v120, v120
    v_exp_f32 v121, v121
    v_mfma_f32_32x32x16_bf16 v[100:115], v[144:147], v[76:79], 0
    v_exp_f32 v122, v122
    v_exp_f32 v123, v123
    v_exp_f32 v124, v124
    v_exp_f32 v125, v125
    v_smfmac_f32_32x32x32_bf16 v[52:67], v[148:151], v[116:123], v72
    v_exp_f32 v126, v126
    v_exp_f32 v127, v127
    v_exp_f32 v128, v128
    v_exp_f32 v129, v129
    v_exp_f32 v130, v130
    v_exp_f32 v131, v131
    s_waitcnt lgkmcnt(0)
    v_exp_f32 v100, v100
    v_exp_f32 v101, v101
    v_smfmac_f32_32x32x32_bf16 v[52:67], v[152:155], v[124:131], v72
    v_exp_f32 v102, v102
    ds_read_b128 v[148:151], v165 offset:1024
    v_exp_f32 v103, v103
    v_exp_f32 v104, v104
    v_exp_f32 v105, v105
    v_mfma_f32_32x32x16_bf16 v[116:131], v[144:147], v[80:83], 0
    v_exp_f32 v106, v106
    ds_read_b128 v[152:155], v165 offset:1280
    v_exp_f32 v107, v107
    v_exp_f32 v108, v108
    v_exp_f32 v109, v109
    v_smfmac_f32_32x32x32_bf16 v[36:51], v[156:159], v[100:107], v72
    v_exp_f32 v110, v110
    ds_read_b128 v[144:147], v164 offset:1024
    v_exp_f32 v111, v111
    v_exp_f32 v112, v112
    v_exp_f32 v113, v113
    v_exp_f32 v114, v114
    v_exp_f32 v115, v115
    v_exp_f32 v116, v116
    v_exp_f32 v117, v117
    v_smfmac_f32_32x32x32_bf16 v[36:51], v[160:163], v[108:115], v72
    v_exp_f32 v118, v118
    v_exp_f32 v119, v119
    v_exp_f32 v120, v120
    v_exp_f32 v121, v121
    v_mfma_f32_32x32x16_bf16 v[100:115], v[140:143], v[76:79], 0
    v_exp_f32 v122, v122
    v_exp_f32 v123, v123
    v_exp_f32 v124, v124
    v_exp_f32 v125, v125
    v_smfmac_f32_32x32x32_bf16 v[52:67], v[156:159], v[116:123], v72
    v_exp_f32 v126, v126
    v_exp_f32 v127, v127
    v_exp_f32 v128, v128
    v_exp_f32 v129, v129
    v_exp_f32 v130, v130
    v_exp_f32 v131, v131
    s_waitcnt lgkmcnt(0)
    v_exp_f32 v100, v100
    v_exp_f32 v101, v101
    v_smfmac_f32_32x32x32_bf16 v[52:67], v[160:163], v[124:131], v72
    v_exp_f32 v102, v102
    ds_read_b128 v[156:159], v165 offset:2048
    v_exp_f32 v103, v103
    v_exp_f32 v104, v104
    v_exp_f32 v105, v105
    v_mfma_f32_32x32x16_bf16 v[116:131], v[140:143], v[80:83], 0
    v_exp_f32 v106, v106
    ds_read_b128 v[160:163], v165 offset:2304
    v_exp_f32 v107, v107
    v_exp_f32 v108, v108
    v_exp_f32 v109, v109
    v_smfmac_f32_32x32x32_bf16 v[36:51], v[148:151], v[100:107], v72
    v_exp_f32 v110, v110
    ds_read_b128 v[140:143], v164 offset:2048
    v_exp_f32 v111, v111
    v_exp_f32 v112, v112
    v_exp_f32 v113, v113
    v_exp_f32 v114, v114
    v_exp_f32 v115, v115
    v_exp_f32 v116, v116
    v_exp_f32 v117, v117
    v_smfmac_f32_32x32x32_bf16 v[36:51], v[152:155], v[108:115], v72
    v_exp_f32 v118, v118
    v_exp_f32 v119, v119
    v_exp_f32 v120, v120
    v_exp_f32 v121, v121
    v_mfma_f32_32x32x16_bf16 v[100:115], v[144:147], v[76:79], 0
    v_exp_f32 v122, v122
    v_exp_f32 v123, v123
    v_exp_f32 v124, v124
    v_exp_f32 v125, v125
    v_smfmac_f32_32x32x32_bf16 v[52:67], v[148:151], v[116:123], v72
    v_exp_f32 v126, v126
    v_exp_f32 v127, v127
    v_exp_f32 v128, v128
    v_exp_f32 v129, v129
    v_exp_f32 v130, v130
    v_exp_f32 v131, v131
    s_waitcnt lgkmcnt(0)
    v_exp_f32 v100, v100
    v_exp_f32 v101, v101
    v_smfmac_f32_32x32x32_bf16 v[52:67], v[152:155], v[124:131], v72
    v_exp_f32 v102, v102
    ds_read_b128 v[148:151], v165 offset:3072
    v_exp_f32 v103, v103
    v_exp_f32 v104, v104
    v_exp_f32 v105, v105
    v_mfma_f32_32x32x16_bf16 v[116:131], v[144:147], v[80:83], 0
    v_exp_f32 v106, v106
    ds_read_b128 v[152:155], v165 offset:3328
    v_exp_f32 v107, v107
    v_exp_f32 v108, v108
    v_exp_f32 v109, v109
    v_smfmac_f32_32x32x32_bf16 v[36:51], v[156:159], v[100:107], v72
    v_exp_f32 v110, v110
    ds_read_b128 v[144:147], v164 offset:3072
    v_exp_f32 v111, v111
    v_exp_f32 v112, v112
    v_exp_f32 v113, v113
    v_exp_f32 v114, v114
    v_exp_f32 v115, v115
    v_add_u32 v164, s45, v164
    v_mad_i32_i24 v165, v166, s45, v165
    s_sub_u32 s45, s46, s45
    s_sub_u32 s46, 0, s46
    s_add_u32 s44, s44, 1
    s_cmp_lt_u32 s44, 8
    v_exp_f32 v116, v116
    v_exp_f32 v117, v117
    v_smfmac_f32_32x32x32_bf16 v[36:51], v[160:163], v[108:115], v72
    v_exp_f32 v118, v118
    v_exp_f32 v119, v119
    v_exp_f32 v120, v120
    v_exp_f32 v121, v121
    v_mfma_f32_32x32x16_bf16 v[100:115], v[140:143], v[76:79], 0
    v_exp_f32 v122, v122
    v_exp_f32 v123, v123
    v_exp_f32 v124, v124
    v_exp_f32 v125, v125
    v_smfmac_f32_32x32x32_bf16 v[52:67], v[156:159], v[116:123], v72
    v_exp_f32 v126, v126
    v_exp_f32 v127, v127
    v_exp_f32 v128, v128
    v_exp_f32 v129, v129
    v_exp_f32 v130, v130
    v_exp_f32 v131, v131
    s_cbranch_scc1 L_aloop
    s_setprio 3
    v_smfmac_f32_32x32x32_bf16 v[52:67], v[160:163], v[124:131], v72
    s_nop 11
    ds_write_b128 v4, v[52:55]
    ds_write_b128 v4, v[56:59] offset:1024
    ds_write_b32 v5, v60 offset:2048
    ds_write_b32 v8, v9
L_pair:
    ds_read_b32 v3, v11 offset:0
    s_waitcnt lgkmcnt(0)
    v_cmp_gt_u32 vcc, s50, v3
    s_nop 0
    s_cbranch_vccz L_pair_ok
    s_sleep 1
    s_branch L_pair
L_pair_ok:
    ds_read_b32 v124, v7 offset:2048
    ds_read_b128 v[116:119], v6
    ds_read_b128 v[120:123], v6 offset:1024
    s_waitcnt lgkmcnt(2)
    v_add_f32 v44, v44, v124
    v_rcp_f32 v2, v44
    v_cmp_nlt_f32 s[56:57], s52, v44
    v_cmp_ngt_f32 s[58:59], s53, v44
    s_waitcnt lgkmcnt(1)
    v_add_f32 v36, v36, v116
    v_add_f32 v37, v37, v117
    v_add_f32 v38, v38, v118
    v_add_f32 v39, v39, v119
    s_waitcnt lgkmcnt(0)
    v_add_f32 v40, v40, v120
    v_add_f32 v41, v41, v121
    v_add_f32 v42, v42, v122
    v_add_f32 v43, v43, v123
    v_add_f32 v116, abs(v36), abs(v37)
    v_add_f32 v117, abs(v38), abs(v39)
    v_add_f32 v118, abs(v40), abs(v41)
    v_add_f32 v119, abs(v42), abs(v43)
    s_or_b64 s[56:57], s[56:57], s[58:59]
    v_add_f32 v116, v116, v117
    v_add_f32 v118, v118, v119
    v_add_f32 v116, v116, v118
    v_cmp_ngt_f32 vcc, s54, v116
    v_mul_f32 v36, v36, v2
    v_mul_f32 v37, v37, v2
    v_mul_f32 v38, v38, v2
    v_mul_f32 v39, v39, v2
    v_mul_f32 v40, v40, v2
    v_mul_f32 v41, v41, v2
    v_mul_f32 v42, v42, v2
    v_mul_f32 v43, v43, v2
    s_or_b64 s[56:57], s[56:57], vcc
    s_cbranch_scc1 L_slow
L_fin:
    v_cvt_pk_bf16_f32 v132, v36, v37
    v_cvt_pk_bf16_f32 v133, v38, v39
    v_cvt_pk_bf16_f32 v134, v40, v41
    v_cvt_pk_bf16_f32 v135, v42, v43
    buffer_store_dwordx4 v[132:135], v1, s[20:23], s55 offen sc1
    s_mov_b32 s48, 327680
    s_mov_b64 exec, 0xff
    s_waitcnt vmcnt(0)
    buffer_store_dwordx2 v[12:13], v10, s[20:23], s48 offen sc1
    s_endpgm
L_itx:
    s_cmp_lg_u32 s44, 1
    s_cbranch_scc1 L_np1
    s_setprio 2
L_np1:
    s_cmp_lg_u32 s44, 4
    s_cbranch_scc1 L_np4
    s_setprio 1
L_np4:
    s_cmp_lg_u32 s44, 7
    s_cbranch_scc1 L_np7
    s_setprio 0
L_np7:
    s_cmp_gt_u32 s44, 4
    s_cbranch_scc1 L_itb
    s_add_u32 s48, s44, 1
    s_cmp_eq_u32 s44, 4
    s_cselect_b32 s50, 8, s48
L_kvw:
    ds_read_b32 v2, v167 offset:64
    s_waitcnt lgkmcnt(0)
    v_cmp_gt_u32 vcc, s50, v2
    s_nop 0
    s_cbranch_vccz L_kvw_ok
    s_sleep 1
    s_branch L_kvw
L_kvw_ok:
    s_cmp_eq_u32 s44, 4
    s_cbranch_scc1 L_it4
    s_cmp_lg_u32 s44, s56
    s_cbranch_scc1 L_itb
    s_waitcnt vmcnt(0)
    v_mov_b32 v4, 1
    s_mov_b64 exec, 1
    ds_add_rtn_u32 v4, v167, v4 offset:52
    s_mov_b64 exec, -1
    s_lshr_b32 s48, s36, 1
    s_lshl_b32 s48, s48, 9
    s_and_b32 s49, s36, 1
    s_add_u32 s49, s49, 1
    s_lshl_b32 s49, s49, 7
    s_add_u32 s48, s48, s49
    v_lshl_add_u32 v6, v0, 12, s48
    s_lshl_b32 s48, s36, 13
    v_and_b32 v5, 15, v0
    v_cmp_gt_u32 vcc, 32, v0
    v_lshl_add_u32 v5, v5, 9, s48
    s_lshl_b32 s48, s37, 3
    v_cndmask_b32 v6, v5, v6, vcc
    v_add_u32 v6, s48, v6
    s_waitcnt lgkmcnt(0)
    v_readfirstlane_b32 s49, v4
    s_nop 0
    s_cmp_lg_u32 s49, 11
    s_cbranch_scc1 L_f2b
    v_mov_b32 v4, s18
    v_mov_b32 v5, s19
    s_mov_b32 s48, 196608
    s_mov_b32 exec_hi, 0xffff
    buffer_store_dwordx2 v[4:5], v6, s[20:23], s48 offen sc1
    s_mov_b64 exec, -1
L_f2b:
    s_branch L_itb
L_it4:
    s_lshl_b32 s48, s38, 2
    s_add_u32 s48, s48, 150528
    v_mov_b32 v8, s48
    v_mov_b32 v3, 200
    ds_write_b32 v8, v3
    s_xor_b32 s49, s38, 12
    s_lshl_b32 s48, s49, 2
    s_add_u32 s48, s48, 150528
    v_mov_b32 v11, s48
    v_mov_b32 v9, 300
    s_mul_i32 s48, s38, 2304
    s_add_u32 s48, s48, 121856
    s_mul_i32 s49, s49, 2304
    s_add_u32 s49, s49, 121856
    v_add_u32 v4, s48, v1
    v_lshl_add_u32 v5, v0, 2, s48
    v_add_u32 v6, s49, v1
    v_lshl_add_u32 v7, v0, 2, s49
    s_lshl_b32 s55, s51, 5
    s_add_u32 s55, s55, s40
    s_lshl_b32 s55, s55, 10
    s_add_u32 s55, s55, 14680064
    s_lshr_b32 s49, s51, 1
    s_lshl_b32 s49, s49, 5
    s_and_b32 s50, s40, 3
    s_add_u32 s49, s49, s50
    s_lshl_b32 s49, s49, 3
    s_lshr_b32 s50, s40, 2
    s_add_u32 s49, s49, s50
    s_lshl_b32 s49, s49, 1
    s_and_b32 s50, s51, 1
    s_add_u32 s49, s49, s50
    s_lshl_b32 s49, s49, 3
    v_lshl_add_u32 v10, v0, 9, s49
    v_mov_b32 v12, s18
    v_mov_b32 v13, s19
    s_movk_i32 s50, 300
    s_mov_b32 s52, 0x21800000
    s_mov_b32 s53, 0x5d800000
    s_mov_b32 s54, 0x7f800000
    s_branch L_itb
L_slow:
    s_lshl_b32 s52, s40, 16
    s_add_u32 s52, s52, 3145728
    s_add_u32 s53, s52, 2097152
    v_and_b32 v2, 15, v0
    v_lshlrev_b32 v2, 4, v2
    v_lshrrev_b32 v3, 5, v0
    v_lshl_add_u32 v2, v3, 9, v2
    v_mov_b32 v5, 0xff800000
    s_mov_b32 s44, 0
    v_mov_b32 v36, 0
    v_mov_b32 v37, 0
    v_mov_b32 v38, 0
    v_mov_b32 v39, 0
    v_mov_b32 v40, 0
    v_mov_b32 v41, 0
    v_mov_b32 v42, 0
    v_mov_b32 v43, 0
    v_mov_b32 v44, 0
    v_mov_b32 v45, 0
    v_mov_b32 v46, 0
    v_mov_b32 v47, 0
    v_mov_b32 v48, 0
    v_mov_b32 v49, 0
    v_mov_b32 v50, 0
    v_mov_b32 v51, 0
    v_mov_b32 v148, 0x3f803f80
    v_mov_b32 v149, 0x3f803f80
    v_mov_b32 v150, 0x3f803f80
    v_mov_b32 v151, 0x3f803f80
    v_mov_b32 v152, 0x3f803f80
    v_mov_b32 v153, 0x3f803f80
    v_mov_b32 v154, 0x3f803f80
    v_mov_b32 v155, 0x3f803f80
L_sloop:
    buffer_load_dwordx4 v[140:143], v1, s[20:23], s52 offen sc1
    s_mov_b32 exec_lo, 0xffff
    s_mov_b32 exec_hi, 0xffff
    buffer_load_dwordx4 v[148:151], v2, s[20:23], s53 offen sc1
    buffer_load_dwordx4 v[152:155], v2, s[20:23], s53 offen offset:256 sc1
    s_mov_b64 exec, -1
    s_add_u32 s52, s52, 1024
    s_add_u32 s53, s53, 1024
    s_waitcnt vmcnt(0)
    v_mfma_f32_32x32x16_bf16 v[100:115], v[140:143], v[76:79], 0
    s_nop 11
    v_max3_f32 v6, v100, v101, v5
    v_max3_f32 v6, v102, v103, v6
    v_max3_f32 v6, v104, v105, v6
    v_max3_f32 v6, v106, v107, v6
    v_max3_f32 v6, v108, v109, v6
    v_max3_f32 v6, v110, v111, v6
    v_max3_f32 v6, v112, v113, v6
    v_max3_f32 v6, v114, v115, v6
    v_mov_b32 v7, v6
    s_nop 1
    v_permlane32_swap_b32 v7, v6
    s_nop 1
    v_max_f32 v6, v6, v7
    v_sub_f32 v7, v5, v6
    v_exp_f32 v7, v7
    v_mov_b32 v5, v6
    v_sub_f32 v100, v100, v6
    v_sub_f32 v101, v101, v6
    v_sub_f32 v102, v102, v6
    v_sub_f32 v103, v103, v6
    v_sub_f32 v104, v104, v6
    v_sub_f32 v105, v105, v6
    v_sub_f32 v106, v106, v6
    v_sub_f32 v107, v107, v6
    v_sub_f32 v108, v108, v6
    v_sub_f32 v109, v109, v6
    v_sub_f32 v110, v110, v6
    v_sub_f32 v111, v111, v6
    v_sub_f32 v112, v112, v6
    v_sub_f32 v113, v113, v6
    v_sub_f32 v114, v114, v6
    v_sub_f32 v115, v115, v6
    v_mul_f32 v36, v36, v7
    v_mul_f32 v37, v37, v7
    v_mul_f32 v38, v38, v7
    v_mul_f32 v39, v39, v7
    v_mul_f32 v40, v40, v7
    v_mul_f32 v41, v41, v7
    v_mul_f32 v42, v42, v7
    v_mul_f32 v43, v43, v7
    v_mul_f32 v44, v44, v7
    v_mul_f32 v45, v45, v7
    v_mul_f32 v46, v46, v7
    v_mul_f32 v47, v47, v7
    v_mul_f32 v48, v48, v7
    v_mul_f32 v49, v49, v7
    v_mul_f32 v50, v50, v7
    v_mul_f32 v51, v51, v7
    v_exp_f32 v100, v100
    v_exp_f32 v101, v101
    v_exp_f32 v102, v102
    v_exp_f32 v103, v103
    v_exp_f32 v104, v104
    v_exp_f32 v105, v105
    v_exp_f32 v106, v106
    v_exp_f32 v107, v107
    v_exp_f32 v108, v108
    v_exp_f32 v109, v109
    v_exp_f32 v110, v110
    v_exp_f32 v111, v111
    v_exp_f32 v112, v112
    v_exp_f32 v113, v113
    v_exp_f32 v114, v114
    v_exp_f32 v115, v115
    s_add_u32 s44, s44, 1
    s_cmp_lt_u32 s44, 64
    v_smfmac_f32_32x32x32_bf16 v[36:51], v[148:151], v[100:107], v72
    v_smfmac_f32_32x32x32_bf16 v[36:51], v[152:155], v[108:115], v72
    s_nop 11
    s_cbranch_scc1 L_sloop
    v_rcp_f32 v2, v44
    s_nop 0
    v_mul_f32 v36, v36, v2
    v_mul_f32 v37, v37, v2
    v_mul_f32 v38, v38, v2
    v_mul_f32 v39, v39, v2
    v_mul_f32 v40, v40, v2
    v_mul_f32 v41, v41, v2
    v_mul_f32 v42, v42, v2
    v_mul_f32 v43, v43, v2
    s_branch L_fin
L_end:
    s_endpgm
.section .rodata,"a"
.p2align 6
.amdhsa_kernel recurrent_scan__softmax_full_mha__dense_activation_relu__prompt_kernel
  .amdhsa_next_free_vgpr 168
  .amdhsa_next_free_sgpr 96
  .amdhsa_accum_offset 168
  .amdhsa_group_segment_fixed_size 0
  .amdhsa_kernarg_size 72
  .amdhsa_user_sgpr_count 2
  .amdhsa_user_sgpr_kernarg_segment_ptr 1
  .amdhsa_system_sgpr_workgroup_id_x 1
  .amdhsa_float_denorm_mode_32 3
.end_amdhsa_kernel
```
